```python
import torch

def _softmax(x, axis=-1):
    return torch.softmax(x, dim=axis)

def _gelu(x):
    return torch.nn.functional.gelu(x, approximate='tanh')

def _silu(x):
    return torch.nn.functional.silu(x)

def _sigmoid(x):
    return torch.sigmoid(x)

def _layernorm(x, axis=-1, eps=1e-05):
    m = x.mean(dim=axis, keepdim=True)
    v = x.var(dim=axis, keepdim=True, unbiased=False)
    return (x - m) / torch.sqrt(v + eps)

def _scatter_add(tgt, idx, src, axis=0):
    return tgt.clone().index_add_(axis, idx, src)

def _segment_sum(src, seg, n):
    out = torch.zeros((n,) + src.shape[1:], dtype=src.dtype)
    return out.index_add_(0, seg, src)

def _pad(x, pw):
    flat = tuple((v for pair in reversed(pw) for v in pair))
    return torch.nn.functional.pad(x, flat)
kernel_name = 'standalone__tree_speculative_verify_tree_attention_over_candidate_token_tree__decode'

def setup_inputs():

    _w = lambda a: (lambda t: t.to(torch.bfloat16) if t.is_floating_point() else t)(torch.as_tensor(a))
    B, Hq, Hkv, T, C, D = (2, 32, 16, 1, 8192, 128)
    tree_mask = torch.zeros((B, T, T), dtype=float)
    for b in range(B):
        parent = torch.zeros(T, dtype=torch.int64)
        for i in range(1, T):
            parent[i] = int(torch.randint(0, i, (1,)).item())
        for i in range(T):
            j = i
            tree_mask[b, i, j] = 1.0
            while j > 0:
                j = parent[j]
                tree_mask[b, i, j] = 1.0
    return {'q': _w((lambda *s: torch.randn(*s, dtype=torch.bfloat16) * 0.8)(B, Hq, T, D)), 'k_cache': _w((lambda *s: torch.randn(*s, dtype=torch.bfloat16) * 0.8)(B, Hkv, C, D)), 'v_cache': _w((lambda *s: torch.randn(*s, dtype=torch.bfloat16) * 0.05)(B, Hkv, C, D)), 'k_tree': _w((lambda *s: torch.randn(*s, dtype=torch.bfloat16) * 0.8)(B, Hkv, T, D)), 'v_tree': _w((lambda *s: torch.randn(*s, dtype=torch.bfloat16) * 0.05)(B, Hkv, T, D)), 'tree_mask': _w(tree_mask)}

def reference(q, k_cache, v_cache, k_tree, v_tree, tree_mask):
    B, Hq, T, D = q.shape
    Hkv, C = (k_cache.shape[1], k_cache.shape[2])
    rep = Hq // Hkv
    kc = (lambda x, n, axis: torch.repeat_interleave(x, n, dim=axis))(k_cache, rep, axis=1)
    vc = (lambda x, n, axis: torch.repeat_interleave(x, n, dim=axis))(v_cache, rep, axis=1)
    kt = (lambda x, n, axis: torch.repeat_interleave(x, n, dim=axis))(k_tree, rep, axis=1)
    vt = (lambda x, n, axis: torch.repeat_interleave(x, n, dim=axis))(v_tree, rep, axis=1)
    k = torch.concatenate([kc, kt], axis=2)
    v = torch.concatenate([vc, vt], axis=2)
    scale = D ** (-0.5)
    scores = torch.einsum('bhqd,bhkd->bhqk', q, k) * scale
    ctx_mask = torch.ones((B, 1, T, C), dtype=scores.dtype)
    tm = tree_mask[:, None, :, :].clone()
    full_mask = torch.concatenate([ctx_mask, tm], axis=-1)
    scores = scores + (1.0 - full_mask) * -1000000000.0
    p = _softmax(scores, axis=-1)
    return torch.einsum('bhqk,bhkd->bhqd', p, v)
```

```asm
; @launch grid=(256,1,1) block=(256,1,1) lds=4352
.amdgcn_target "amdgcn-amd-amdhsa--gfx950"
.text
.p2align 13
.globl standalone__tree_speculative_verify_tree_attention_over_candidate_token_tree__decode_kernel
.p2align 8
.type standalone__tree_speculative_verify_tree_attention_over_candidate_token_tree__decode_kernel,@function
standalone__tree_speculative_verify_tree_attention_over_candidate_token_tree__decode_kernel:
    s_load_dwordx2 s[4:5], s[0:1], 8
    s_load_dwordx2 s[12:13], s[0:1], 0
    s_load_dwordx2 s[8:9], s[0:1], 16
    s_load_dwordx2 s[16:17], s[0:1], 24
    s_load_dwordx2 s[20:21], s[0:1], 32
    s_load_dwordx2 s[36:37], s[0:1], 40
    s_cmp_ge_u32 s2, 256
    s_cbranch_scc1 L_end
    s_and_b32 s45, s2, 7
    s_lshl_b32 s45, s45, 5
    s_lshr_b32 s41, s2, 3
    s_or_b32 s45, s45, s41
    s_lshl_b32 s47, s45, 18
    s_lshr_b32 s40, s45, 3
    s_and_b32 s41, s41, 7
    v_and_b32 v37, 3, v0
    v_bfe_u32 v36, v0, 4, 2
    v_lshlrev_b32 v36, 6, v36
    v_lshl_add_u32 v37, v37, 4, v36
    v_bfe_u32 v36, v0, 2, 2
    v_lshl_add_u32 v1, v36, 8, v37
    v_lshrrev_b32 v3, 6, v0
    v_lshl_add_u32 v1, v3, 10, v1
    v_bfe_u32 v36, v0, 3, 1
    v_lshl_add_u32 v36, v36, 8, v37
    s_lshl_b32 s45, s40, 9
    s_mov_b32 s6, 0x4000000
    s_mov_b32 s7, 0x20000
    s_movk_i32 s14, 0x4000
    s_mov_b32 s15, 0x20000
    s_mov_b32 s48, s47
    s_waitcnt lgkmcnt(0)
    buffer_load_dwordx4 v[4:7], v36, s[12:15], s45 offen
    buffer_load_dwordx4 v[124:127], v1, s[4:7], s47 offen nt
    s_add_u32 s47, s47, 0x1000
    buffer_load_dwordx4 v[128:131], v1, s[4:7], s47 offen nt
    s_add_u32 s47, s47, 0x1000
    buffer_load_dwordx4 v[132:135], v1, s[4:7], s47 offen nt
    s_add_u32 s47, s47, 0x1000
    buffer_load_dwordx4 v[136:139], v1, s[4:7], s47 offen nt
    s_add_u32 s47, s47, 0x1000
    buffer_load_dwordx4 v[140:143], v1, s[4:7], s47 offen nt
    s_add_u32 s47, s47, 0x1000
    buffer_load_dwordx4 v[144:147], v1, s[4:7], s47 offen nt
    s_add_u32 s47, s47, 0x1000
    buffer_load_dwordx4 v[148:151], v1, s[4:7], s47 offen nt
    s_add_u32 s47, s47, 0x1000
    buffer_load_dwordx4 v[152:155], v1, s[4:7], s47 offen nt
    s_add_u32 s47, s47, 0x1000
    buffer_load_dwordx4 v[156:159], v1, s[4:7], s47 offen nt
    s_add_u32 s47, s47, 0x1000
    buffer_load_dwordx4 v[160:163], v1, s[4:7], s47 offen nt
    s_add_u32 s47, s47, 0x1000
    buffer_load_dwordx4 v[164:167], v1, s[4:7], s47 offen nt
    s_add_u32 s47, s47, 0x1000
    buffer_load_dwordx4 v[168:171], v1, s[4:7], s47 offen nt
    s_add_u32 s47, s47, 0x1000
    buffer_load_dwordx4 v[172:175], v1, s[4:7], s47 offen nt
    s_add_u32 s47, s47, 0x1000
    buffer_load_dwordx4 v[176:179], v1, s[4:7], s47 offen nt
    s_add_u32 s47, s47, 0x1000
    buffer_load_dwordx4 v[180:183], v1, s[4:7], s47 offen nt
    s_add_u32 s47, s47, 0x1000
    buffer_load_dwordx4 v[184:187], v1, s[4:7], s47 offen nt
    s_add_u32 s47, s47, 0x1000
    buffer_load_dwordx4 v[188:191], v1, s[4:7], s47 offen nt
    s_add_u32 s47, s47, 0x1000
    buffer_load_dwordx4 v[192:195], v1, s[4:7], s47 offen nt
    s_add_u32 s47, s47, 0x1000
    buffer_load_dwordx4 v[196:199], v1, s[4:7], s47 offen nt
    s_add_u32 s47, s47, 0x1000
    buffer_load_dwordx4 v[200:203], v1, s[4:7], s47 offen nt
    s_add_u32 s47, s47, 0x1000
    buffer_load_dwordx4 v[204:207], v1, s[4:7], s47 offen nt
    s_add_u32 s47, s47, 0x1000
    buffer_load_dwordx4 v[208:211], v1, s[4:7], s47 offen nt
    s_add_u32 s47, s47, 0x1000
    buffer_load_dwordx4 v[212:215], v1, s[4:7], s47 offen nt
    s_add_u32 s47, s47, 0x1000
    buffer_load_dwordx4 v[216:219], v1, s[4:7], s47 offen nt
    s_load_dword s43, s[36:37], 0
    s_load_dwordx2 s[24:25], s[0:1], 48
    s_load_dwordx2 s[28:29], s[0:1], 56
    s_load_dwordx2 s[32:33], s[0:1], 64
    s_mov_b32 s10, 0x4000000
    s_mov_b32 s11, 0x20000
    s_mov_b32 s18, 0x2000
    s_mov_b32 s19, 0x20000
    s_mov_b32 s22, 0x2000
    s_mov_b32 s23, 0x20000
    s_mov_b32 s26, 0x4000
    s_mov_b32 s27, 0x20000
    s_mov_b32 s30, 0x100
    s_mov_b32 s31, 0x20000
    s_mov_b32 s34, 0x108000
    s_mov_b32 s35, 0x20000
    v_and_b32 v44, 63, v0
    v_lshlrev_b32 v2, 4, v0
    v_readfirstlane_b32 s42, v3
    s_lshl_b32 s46, s40, 8
    v_and_b32 v36, 15, v0
    v_lshlrev_b32 v36, 4, v36
    buffer_load_dwordx4 v[24:27], v37, s[16:19], s46 offen
    buffer_load_dwordx4 v[28:31], v36, s[20:23], s46 offen
    s_mov_b32 s44, 0x3e0293ee
    v_bfe_u32 v36, v0, 3, 1
    v_lshlrev_b32 v36, 4, v36
    v_lshl_add_u32 v45, v3, 2, v36
    v_and_b32 v3, 1, v0
    v_lshlrev_b32 v3, 4, v3
    v_mov_b32 v36, 0xffff
    v_lshlrev_b32 v36, v3, v36
    v_bfe_u32 v3, v0, 1, 2
    v_cmp_eq_u32 vcc, 0, v3
    s_nop 1
    v_cndmask_b32 v32, 0, v36, vcc
    v_cmp_eq_u32 vcc, 1, v3
    s_nop 1
    v_cndmask_b32 v33, 0, v36, vcc
    v_cmp_eq_u32 vcc, 2, v3
    s_nop 1
    v_cndmask_b32 v34, 0, v36, vcc
    v_cmp_eq_u32 vcc, 3, v3
    s_nop 1
    v_cndmask_b32 v35, 0, v36, vcc
    v_mov_b32 v40, 0
    v_mov_b32 v41, 0
    v_mov_b32 v42, 0
    v_mov_b32 v43, 0
    v_lshlrev_b32 v56, 4, v44
    s_getreg_b32 s38, hwreg(HW_REG_XCC_ID, 0, 3)
    s_lshl_b32 s62, s38, 2
    s_lshl_b32 s45, 1, s62
    s_lshl_b32 s62, 7, s62
    v_mov_b32 v57, s45
    s_lshl_b32 s51, s40, 15
    s_lshl_b32 s50, s41, 7
    s_or_b32 s50, s50, s51
    s_lshl_b32 s49, s41, 10
    s_or_b32 s49, s49, s51
    s_lshr_b32 s63, s48, 12
    s_lshl_b32 s58, s40, 3
    s_lshl_b32 s61, s40, 9
    s_add_u32 s61, s61, 0x100000
    s_lshl_b32 s39, s41, 5
    s_add_u32 s39, s39, s61
    s_movk_i32 s60, 0x7fff
    s_waitcnt lgkmcnt(0)
    s_and_b32 s45, s40, 16
    s_lshr_b32 s43, s43, s45
    s_lshl_b32 s43, s43, 16
    v_mov_b32 v38, s43
    v_sub_f32 v38, 1.0, v38
    v_mul_f32 v38, 0xd028965f, v38
    s_cmp_eq_u32 s41, 0
    s_cselect_b32 s45, 16, 0
    v_mov_b32 v3, 0xff800000
    v_cmp_gt_u32 vcc, s45, v0
    s_nop 1
    v_cndmask_b32 v38, v3, v38, vcc
    s_waitcnt vmcnt(25)
    v_mfma_f32_16x16x32_bf16 v[8:11], v[124:127], v[4:7], 0
    s_add_u32 s47, s47, 0x1000
    buffer_load_dwordx4 v[124:127], v1, s[4:7], s47 offen nt
    s_waitcnt vmcnt(25)
    v_mfma_f32_16x16x32_bf16 v[12:15], v[128:131], v[4:7], 0
    s_add_u32 s47, s47, 0x1000
    buffer_load_dwordx4 v[128:131], v1, s[4:7], s47 offen nt
    s_waitcnt vmcnt(25)
    v_mfma_f32_16x16x32_bf16 v[16:19], v[132:135], v[4:7], 0
    s_add_u32 s47, s47, 0x1000
    buffer_load_dwordx4 v[132:135], v1, s[4:7], s47 offen nt
    v_mov_b32_dpp v59, v8 quad_perm:[0,0,0,0] row_mask:0xf bank_mask:0xf
    v_add_f32_dpp v59, v9, v59 quad_perm:[1,1,1,1] row_mask:0xf bank_mask:0xf
    v_add_f32_dpp v59, v10, v59 quad_perm:[2,2,2,2] row_mask:0xf bank_mask:0xf
    v_add_f32_dpp v59, v11, v59 quad_perm:[3,3,3,3] row_mask:0xf bank_mask:0xf
    s_waitcnt vmcnt(25)
    v_mfma_f32_16x16x32_bf16 v[20:23], v[136:139], v[4:7], 0
    s_add_u32 s47, s47, 0x1000
    buffer_load_dwordx4 v[136:139], v1, s[4:7], s47 offen nt
    v_mov_b32_dpp v60, v12 quad_perm:[0,0,0,0] row_mask:0xf bank_mask:0xf
    v_add_f32_dpp v60, v13, v60 quad_perm:[1,1,1,1] row_mask:0xf bank_mask:0xf
    v_add_f32_dpp v60, v14, v60 quad_perm:[2,2,2,2] row_mask:0xf bank_mask:0xf
    v_add_f32_dpp v60, v15, v60 quad_perm:[3,3,3,3] row_mask:0xf bank_mask:0xf
    v_max_f32 v46, v59, v60
    s_waitcnt vmcnt(25)
    v_mfma_f32_16x16x32_bf16 v[8:11], v[140:143], v[4:7], 0
    s_add_u32 s47, s47, 0x1000
    buffer_load_dwordx4 v[140:143], v1, s[4:7], s47 offen nt
    v_mov_b32_dpp v61, v16 quad_perm:[0,0,0,0] row_mask:0xf bank_mask:0xf
    v_add_f32_dpp v61, v17, v61 quad_perm:[1,1,1,1] row_mask:0xf bank_mask:0xf
    v_add_f32_dpp v61, v18, v61 quad_perm:[2,2,2,2] row_mask:0xf bank_mask:0xf
    v_add_f32_dpp v61, v19, v61 quad_perm:[3,3,3,3] row_mask:0xf bank_mask:0xf
    s_waitcnt vmcnt(25)
    v_mfma_f32_16x16x32_bf16 v[12:15], v[144:147], v[4:7], 0
    s_add_u32 s47, s47, 0x1000
    buffer_load_dwordx4 v[144:147], v1, s[4:7], s47 offen nt
    v_mov_b32_dpp v62, v20 quad_perm:[0,0,0,0] row_mask:0xf bank_mask:0xf
    v_add_f32_dpp v62, v21, v62 quad_perm:[1,1,1,1] row_mask:0xf bank_mask:0xf
    v_add_f32_dpp v62, v22, v62 quad_perm:[2,2,2,2] row_mask:0xf bank_mask:0xf
    v_add_f32_dpp v62, v23, v62 quad_perm:[3,3,3,3] row_mask:0xf bank_mask:0xf
    v_max3_f32 v46, v46, v61, v62
    s_waitcnt vmcnt(25)
    v_mfma_f32_16x16x32_bf16 v[16:19], v[148:151], v[4:7], 0
    s_add_u32 s47, s47, 0x1000
    buffer_load_dwordx4 v[148:151], v1, s[4:7], s47 offen nt
    v_mov_b32_dpp v63, v8 quad_perm:[0,0,0,0] row_mask:0xf bank_mask:0xf
    v_add_f32_dpp v63, v9, v63 quad_perm:[1,1,1,1] row_mask:0xf bank_mask:0xf
    v_add_f32_dpp v63, v10, v63 quad_perm:[2,2,2,2] row_mask:0xf bank_mask:0xf
    v_add_f32_dpp v63, v11, v63 quad_perm:[3,3,3,3] row_mask:0xf bank_mask:0xf
    s_waitcnt vmcnt(25)
    v_mfma_f32_16x16x32_bf16 v[20:23], v[152:155], v[4:7], 0
    s_add_u32 s47, s47, 0x1000
    buffer_load_dwordx4 v[152:155], v1, s[4:7], s47 offen nt
    v_mov_b32_dpp v64, v12 quad_perm:[0,0,0,0] row_mask:0xf bank_mask:0xf
    v_add_f32_dpp v64, v13, v64 quad_perm:[1,1,1,1] row_mask:0xf bank_mask:0xf
    v_add_f32_dpp v64, v14, v64 quad_perm:[2,2,2,2] row_mask:0xf bank_mask:0xf
    v_add_f32_dpp v64, v15, v64 quad_perm:[3,3,3,3] row_mask:0xf bank_mask:0xf
    v_max3_f32 v46, v46, v63, v64
    s_waitcnt vmcnt(25)
    v_mfma_f32_16x16x32_bf16 v[8:11], v[156:159], v[4:7], 0
    s_add_u32 s47, s47, 0x1000
    buffer_load_dwordx4 v[156:159], v1, s[4:7], s47 offen nt
    v_mov_b32_dpp v65, v16 quad_perm:[0,0,0,0] row_mask:0xf bank_mask:0xf
    v_add_f32_dpp v65, v17, v65 quad_perm:[1,1,1,1] row_mask:0xf bank_mask:0xf
    v_add_f32_dpp v65, v18, v65 quad_perm:[2,2,2,2] row_mask:0xf bank_mask:0xf
    v_add_f32_dpp v65, v19, v65 quad_perm:[3,3,3,3] row_mask:0xf bank_mask:0xf
    s_waitcnt vmcnt(25)
    v_mfma_f32_16x16x32_bf16 v[12:15], v[160:163], v[4:7], 0
    s_add_u32 s47, s47, 0x1000
    buffer_load_dwordx4 v[160:163], v1, s[4:7], s47 offen nt
    v_mov_b32_dpp v66, v20 quad_perm:[0,0,0,0] row_mask:0xf bank_mask:0xf
    v_add_f32_dpp v66, v21, v66 quad_perm:[1,1,1,1] row_mask:0xf bank_mask:0xf
    v_add_f32_dpp v66, v22, v66 quad_perm:[2,2,2,2] row_mask:0xf bank_mask:0xf
    v_add_f32_dpp v66, v23, v66 quad_perm:[3,3,3,3] row_mask:0xf bank_mask:0xf
    v_max3_f32 v46, v46, v65, v66
    s_waitcnt vmcnt(25)
    v_mfma_f32_16x16x32_bf16 v[16:19], v[164:167], v[4:7], 0
    s_add_u32 s47, s47, 0x1000
    buffer_load_dwordx4 v[164:167], v1, s[4:7], s47 offen nt
    v_mov_b32_dpp v67, v8 quad_perm:[0,0,0,0] row_mask:0xf bank_mask:0xf
    v_add_f32_dpp v67, v9, v67 quad_perm:[1,1,1,1] row_mask:0xf bank_mask:0xf
    v_add_f32_dpp v67, v10, v67 quad_perm:[2,2,2,2] row_mask:0xf bank_mask:0xf
    v_add_f32_dpp v67, v11, v67 quad_perm:[3,3,3,3] row_mask:0xf bank_mask:0xf
    s_waitcnt vmcnt(25)
    v_mfma_f32_16x16x32_bf16 v[20:23], v[168:171], v[4:7], 0
    s_add_u32 s47, s47, 0x1000
    buffer_load_dwordx4 v[168:171], v1, s[4:7], s47 offen nt
    v_mov_b32_dpp v68, v12 quad_perm:[0,0,0,0] row_mask:0xf bank_mask:0xf
    v_add_f32_dpp v68, v13, v68 quad_perm:[1,1,1,1] row_mask:0xf bank_mask:0xf
    v_add_f32_dpp v68, v14, v68 quad_perm:[2,2,2,2] row_mask:0xf bank_mask:0xf
    v_add_f32_dpp v68, v15, v68 quad_perm:[3,3,3,3] row_mask:0xf bank_mask:0xf
    v_max3_f32 v46, v46, v67, v68
    s_waitcnt vmcnt(25)
    v_mfma_f32_16x16x32_bf16 v[8:11], v[172:175], v[4:7], 0
    s_add_u32 s47, s47, 0x1000
    buffer_load_dwordx4 v[172:175], v1, s[4:7], s47 offen nt
    v_mov_b32_dpp v69, v16 quad_perm:[0,0,0,0] row_mask:0xf bank_mask:0xf
    v_add_f32_dpp v69, v17, v69 quad_perm:[1,1,1,1] row_mask:0xf bank_mask:0xf
    v_add_f32_dpp v69, v18, v69 quad_perm:[2,2,2,2] row_mask:0xf bank_mask:0xf
    v_add_f32_dpp v69, v19, v69 quad_perm:[3,3,3,3] row_mask:0xf bank_mask:0xf
    s_waitcnt vmcnt(25)
    v_mfma_f32_16x16x32_bf16 v[12:15], v[176:179], v[4:7], 0
    s_add_u32 s47, s47, 0x1000
    buffer_load_dwordx4 v[176:179], v1, s[4:7], s47 offen nt
    v_mov_b32_dpp v70, v20 quad_perm:[0,0,0,0] row_mask:0xf bank_mask:0xf
    v_add_f32_dpp v70, v21, v70 quad_perm:[1,1,1,1] row_mask:0xf bank_mask:0xf
    v_add_f32_dpp v70, v22, v70 quad_perm:[2,2,2,2] row_mask:0xf bank_mask:0xf
    v_add_f32_dpp v70, v23, v70 quad_perm:[3,3,3,3] row_mask:0xf bank_mask:0xf
    v_max3_f32 v46, v46, v69, v70
    s_waitcnt vmcnt(25)
    v_mfma_f32_16x16x32_bf16 v[16:19], v[180:183], v[4:7], 0
    s_add_u32 s47, s47, 0x1000
    buffer_load_dwordx4 v[180:183], v1, s[4:7], s47 offen nt
    v_mov_b32_dpp v71, v8 quad_perm:[0,0,0,0] row_mask:0xf bank_mask:0xf
    v_add_f32_dpp v71, v9, v71 quad_perm:[1,1,1,1] row_mask:0xf bank_mask:0xf
    v_add_f32_dpp v71, v10, v71 quad_perm:[2,2,2,2] row_mask:0xf bank_mask:0xf
    v_add_f32_dpp v71, v11, v71 quad_perm:[3,3,3,3] row_mask:0xf bank_mask:0xf
    s_waitcnt vmcnt(25)
    v_mfma_f32_16x16x32_bf16 v[20:23], v[184:187], v[4:7], 0
    s_add_u32 s47, s47, 0x1000
    buffer_load_dwordx4 v[184:187], v1, s[4:7], s47 offen nt
    v_mov_b32_dpp v72, v12 quad_perm:[0,0,0,0] row_mask:0xf bank_mask:0xf
    v_add_f32_dpp v72, v13, v72 quad_perm:[1,1,1,1] row_mask:0xf bank_mask:0xf
    v_add_f32_dpp v72, v14, v72 quad_perm:[2,2,2,2] row_mask:0xf bank_mask:0xf
    v_add_f32_dpp v72, v15, v72 quad_perm:[3,3,3,3] row_mask:0xf bank_mask:0xf
    v_max3_f32 v46, v46, v71, v72
    s_waitcnt vmcnt(25)
    v_mfma_f32_16x16x32_bf16 v[8:11], v[188:191], v[4:7], 0
    s_add_u32 s47, s47, 0x1000
    buffer_load_dwordx4 v[188:191], v1, s[4:7], s47 offen nt
    v_mov_b32_dpp v73, v16 quad_perm:[0,0,0,0] row_mask:0xf bank_mask:0xf
    v_add_f32_dpp v73, v17, v73 quad_perm:[1,1,1,1] row_mask:0xf bank_mask:0xf
    v_add_f32_dpp v73, v18, v73 quad_perm:[2,2,2,2] row_mask:0xf bank_mask:0xf
    v_add_f32_dpp v73, v19, v73 quad_perm:[3,3,3,3] row_mask:0xf bank_mask:0xf
    s_waitcnt vmcnt(25)
    v_mfma_f32_16x16x32_bf16 v[12:15], v[192:195], v[4:7], 0
    s_add_u32 s47, s47, 0x1000
    buffer_load_dwordx4 v[192:195], v1, s[4:7], s47 offen nt
    v_mov_b32_dpp v74, v20 quad_perm:[0,0,0,0] row_mask:0xf bank_mask:0xf
    v_add_f32_dpp v74, v21, v74 quad_perm:[1,1,1,1] row_mask:0xf bank_mask:0xf
    v_add_f32_dpp v74, v22, v74 quad_perm:[2,2,2,2] row_mask:0xf bank_mask:0xf
    v_add_f32_dpp v74, v23, v74 quad_perm:[3,3,3,3] row_mask:0xf bank_mask:0xf
    v_max3_f32 v46, v46, v73, v74
    s_waitcnt vmcnt(25)
    v_mfma_f32_16x16x32_bf16 v[16:19], v[196:199], v[4:7], 0
    s_add_u32 s47, s47, 0x1000
    buffer_load_dwordx4 v[196:199], v1, s[4:7], s47 offen nt
    v_mov_b32_dpp v75, v8 quad_perm:[0,0,0,0] row_mask:0xf bank_mask:0xf
    v_add_f32_dpp v75, v9, v75 quad_perm:[1,1,1,1] row_mask:0xf bank_mask:0xf
    v_add_f32_dpp v75, v10, v75 quad_perm:[2,2,2,2] row_mask:0xf bank_mask:0xf
    v_add_f32_dpp v75, v11, v75 quad_perm:[3,3,3,3] row_mask:0xf bank_mask:0xf
    s_waitcnt vmcnt(25)
    v_mfma_f32_16x16x32_bf16 v[20:23], v[200:203], v[4:7], 0
    s_add_u32 s47, s47, 0x1000
    buffer_load_dwordx4 v[200:203], v1, s[4:7], s47 offen nt
    v_mov_b32_dpp v76, v12 quad_perm:[0,0,0,0] row_mask:0xf bank_mask:0xf
    v_add_f32_dpp v76, v13, v76 quad_perm:[1,1,1,1] row_mask:0xf bank_mask:0xf
    v_add_f32_dpp v76, v14, v76 quad_perm:[2,2,2,2] row_mask:0xf bank_mask:0xf
    v_add_f32_dpp v76, v15, v76 quad_perm:[3,3,3,3] row_mask:0xf bank_mask:0xf
    v_max3_f32 v46, v46, v75, v76
    s_waitcnt vmcnt(25)
    v_mfma_f32_16x16x32_bf16 v[8:11], v[204:207], v[4:7], 0
    s_add_u32 s47, s47, 0x1000
    buffer_load_dwordx4 v[204:207], v1, s[4:7], s47 offen nt
    v_mov_b32_dpp v77, v16 quad_perm:[0,0,0,0] row_mask:0xf bank_mask:0xf
    v_add_f32_dpp v77, v17, v77 quad_perm:[1,1,1,1] row_mask:0xf bank_mask:0xf
    v_add_f32_dpp v77, v18, v77 quad_perm:[2,2,2,2] row_mask:0xf bank_mask:0xf
    v_add_f32_dpp v77, v19, v77 quad_perm:[3,3,3,3] row_mask:0xf bank_mask:0xf
    s_waitcnt vmcnt(25)
    v_mfma_f32_16x16x32_bf16 v[12:15], v[208:211], v[4:7], 0
    s_add_u32 s47, s47, 0x1000
    buffer_load_dwordx4 v[208:211], v1, s[4:7], s47 offen nt
    v_mov_b32_dpp v78, v20 quad_perm:[0,0,0,0] row_mask:0xf bank_mask:0xf
    v_add_f32_dpp v78, v21, v78 quad_perm:[1,1,1,1] row_mask:0xf bank_mask:0xf
    v_add_f32_dpp v78, v22, v78 quad_perm:[2,2,2,2] row_mask:0xf bank_mask:0xf
    v_add_f32_dpp v78, v23, v78 quad_perm:[3,3,3,3] row_mask:0xf bank_mask:0xf
    v_max3_f32 v46, v46, v77, v78
    s_waitcnt vmcnt(25)
    v_mfma_f32_16x16x32_bf16 v[16:19], v[212:215], v[4:7], 0
    s_add_u32 s47, s47, 0x1000
    buffer_load_dwordx4 v[212:215], v1, s[4:7], s47 offen nt
    v_mov_b32_dpp v79, v8 quad_perm:[0,0,0,0] row_mask:0xf bank_mask:0xf
    v_add_f32_dpp v79, v9, v79 quad_perm:[1,1,1,1] row_mask:0xf bank_mask:0xf
    v_add_f32_dpp v79, v10, v79 quad_perm:[2,2,2,2] row_mask:0xf bank_mask:0xf
    v_add_f32_dpp v79, v11, v79 quad_perm:[3,3,3,3] row_mask:0xf bank_mask:0xf
    s_waitcnt vmcnt(25)
    v_mfma_f32_16x16x32_bf16 v[20:23], v[216:219], v[4:7], 0
    s_add_u32 s47, s47, 0x1000
    buffer_load_dwordx4 v[216:219], v1, s[4:7], s47 offen nt
    v_mov_b32_dpp v80, v12 quad_perm:[0,0,0,0] row_mask:0xf bank_mask:0xf
    v_add_f32_dpp v80, v13, v80 quad_perm:[1,1,1,1] row_mask:0xf bank_mask:0xf
    v_add_f32_dpp v80, v14, v80 quad_perm:[2,2,2,2] row_mask:0xf bank_mask:0xf
    v_add_f32_dpp v80, v15, v80 quad_perm:[3,3,3,3] row_mask:0xf bank_mask:0xf
    v_max3_f32 v46, v46, v79, v80
    s_waitcnt vmcnt(23)
    v_mfma_f32_16x16x32_bf16 v[8:11], v[124:127], v[4:7], 0
    s_add_u32 s47, s47, 0x1000
    buffer_load_dwordx4 v[124:127], v1, s[4:7], s47 offen nt
    v_mov_b32_dpp v81, v16 quad_perm:[0,0,0,0] row_mask:0xf bank_mask:0xf
    v_add_f32_dpp v81, v17, v81 quad_perm:[1,1,1,1] row_mask:0xf bank_mask:0xf
    v_add_f32_dpp v81, v18, v81 quad_perm:[2,2,2,2] row_mask:0xf bank_mask:0xf
    v_add_f32_dpp v81, v19, v81 quad_perm:[3,3,3,3] row_mask:0xf bank_mask:0xf
    s_waitcnt vmcnt(23)
    v_mfma_f32_16x16x32_bf16 v[12:15], v[128:131], v[4:7], 0
    s_add_u32 s47, s47, 0x1000
    buffer_load_dwordx4 v[128:131], v1, s[4:7], s47 offen nt
    v_mov_b32_dpp v82, v20 quad_perm:[0,0,0,0] row_mask:0xf bank_mask:0xf
    v_add_f32_dpp v82, v21, v82 quad_perm:[1,1,1,1] row_mask:0xf bank_mask:0xf
    v_add_f32_dpp v82, v22, v82 quad_perm:[2,2,2,2] row_mask:0xf bank_mask:0xf
    v_add_f32_dpp v82, v23, v82 quad_perm:[3,3,3,3] row_mask:0xf bank_mask:0xf
    v_max3_f32 v46, v46, v81, v82
    v_mfma_f32_16x16x32_bf16 v[16:19], v[24:27], v[4:7], 0
    v_mov_b32_dpp v83, v8 quad_perm:[0,0,0,0] row_mask:0xf bank_mask:0xf
    v_add_f32_dpp v83, v9, v83 quad_perm:[1,1,1,1] row_mask:0xf bank_mask:0xf
    v_add_f32_dpp v83, v10, v83 quad_perm:[2,2,2,2] row_mask:0xf bank_mask:0xf
    v_add_f32_dpp v83, v11, v83 quad_perm:[3,3,3,3] row_mask:0xf bank_mask:0xf
    s_waitcnt vmcnt(23)
    v_mfma_f32_16x16x32_bf16 v[20:23], v[132:135], v[4:7], 0
    s_add_u32 s47, s47, 0x1000
    buffer_load_dwordx4 v[132:135], v1, s[4:7], s47 offen nt
    v_mov_b32_dpp v84, v12 quad_perm:[0,0,0,0] row_mask:0xf bank_mask:0xf
    v_add_f32_dpp v84, v13, v84 quad_perm:[1,1,1,1] row_mask:0xf bank_mask:0xf
    v_add_f32_dpp v84, v14, v84 quad_perm:[2,2,2,2] row_mask:0xf bank_mask:0xf
    v_add_f32_dpp v84, v15, v84 quad_perm:[3,3,3,3] row_mask:0xf bank_mask:0xf
    v_max3_f32 v46, v46, v83, v84
    s_waitcnt vmcnt(23)
    v_mfma_f32_16x16x32_bf16 v[8:11], v[136:139], v[4:7], 0
    s_add_u32 s47, s47, 0x1000
    buffer_load_dwordx4 v[136:139], v1, s[4:7], s47 offen nt
    v_mov_b32_dpp v123, v16 quad_perm:[0,0,0,0] row_mask:0xf bank_mask:0xf
    v_add_f32_dpp v123, v17, v123 quad_perm:[1,1,1,1] row_mask:0xf bank_mask:0xf
    v_add_f32_dpp v123, v18, v123 quad_perm:[2,2,2,2] row_mask:0xf bank_mask:0xf
    v_add_f32_dpp v123, v19, v123 quad_perm:[3,3,3,3] row_mask:0xf bank_mask:0xf
    v_add_f32 v123, v123, v38
    s_waitcnt vmcnt(23)
    v_mfma_f32_16x16x32_bf16 v[12:15], v[140:143], v[4:7], 0
    s_add_u32 s47, s47, 0x1000
    buffer_load_dwordx4 v[140:143], v1, s[4:7], s47 offen nt
    v_mov_b32_dpp v85, v20 quad_perm:[0,0,0,0] row_mask:0xf bank_mask:0xf
    v_add_f32_dpp v85, v21, v85 quad_perm:[1,1,1,1] row_mask:0xf bank_mask:0xf
    v_add_f32_dpp v85, v22, v85 quad_perm:[2,2,2,2] row_mask:0xf bank_mask:0xf
    v_add_f32_dpp v85, v23, v85 quad_perm:[3,3,3,3] row_mask:0xf bank_mask:0xf
    v_max3_f32 v46, v46, v123, v85
    s_waitcnt vmcnt(23)
    v_mfma_f32_16x16x32_bf16 v[16:19], v[144:147], v[4:7], 0
    s_add_u32 s47, s47, 0x1000
    buffer_load_dwordx4 v[144:147], v1, s[4:7], s47 offen nt
    v_mov_b32_dpp v86, v8 quad_perm:[0,0,0,0] row_mask:0xf bank_mask:0xf
    v_add_f32_dpp v86, v9, v86 quad_perm:[1,1,1,1] row_mask:0xf bank_mask:0xf
    v_add_f32_dpp v86, v10, v86 quad_perm:[2,2,2,2] row_mask:0xf bank_mask:0xf
    v_add_f32_dpp v86, v11, v86 quad_perm:[3,3,3,3] row_mask:0xf bank_mask:0xf
    s_waitcnt vmcnt(23)
    v_mfma_f32_16x16x32_bf16 v[20:23], v[148:151], v[4:7], 0
    s_add_u32 s47, s47, 0x1000
    buffer_load_dwordx4 v[148:151], v1, s[4:7], s47 offen nt
    s_cmp_lg_u32 s42, 0
    s_cbranch_scc1 L_skip_ep
    v_lshlrev_b32 v52, 2, v44
    buffer_load_dword v220, off, s[32:35], s61 offset:256 sc1
    buffer_load_dword v53, v52, s[32:35], s61 offen sc1
L_skip_ep:
    v_mov_b32_dpp v87, v12 quad_perm:[0,0,0,0] row_mask:0xf bank_mask:0xf
    v_add_f32_dpp v87, v13, v87 quad_perm:[1,1,1,1] row_mask:0xf bank_mask:0xf
    v_add_f32_dpp v87, v14, v87 quad_perm:[2,2,2,2] row_mask:0xf bank_mask:0xf
    v_add_f32_dpp v87, v15, v87 quad_perm:[3,3,3,3] row_mask:0xf bank_mask:0xf
    v_max3_f32 v46, v46, v86, v87
    s_waitcnt vmcnt(23)
    v_mfma_f32_16x16x32_bf16 v[8:11], v[152:155], v[4:7], 0
    s_add_u32 s47, s47, 0x1000
    buffer_load_dwordx4 v[152:155], v1, s[4:7], s47 offen nt
    v_mov_b32_dpp v88, v16 quad_perm:[0,0,0,0] row_mask:0xf bank_mask:0xf
    v_add_f32_dpp v88, v17, v88 quad_perm:[1,1,1,1] row_mask:0xf bank_mask:0xf
    v_add_f32_dpp v88, v18, v88 quad_perm:[2,2,2,2] row_mask:0xf bank_mask:0xf
    v_add_f32_dpp v88, v19, v88 quad_perm:[3,3,3,3] row_mask:0xf bank_mask:0xf
    s_waitcnt vmcnt(23)
    v_mfma_f32_16x16x32_bf16 v[12:15], v[156:159], v[4:7], 0
    s_add_u32 s47, s47, 0x1000
    buffer_load_dwordx4 v[156:159], v1, s[4:7], s47 offen nt
    v_mov_b32_dpp v89, v20 quad_perm:[0,0,0,0] row_mask:0xf bank_mask:0xf
    v_add_f32_dpp v89, v21, v89 quad_perm:[1,1,1,1] row_mask:0xf bank_mask:0xf
    v_add_f32_dpp v89, v22, v89 quad_perm:[2,2,2,2] row_mask:0xf bank_mask:0xf
    v_add_f32_dpp v89, v23, v89 quad_perm:[3,3,3,3] row_mask:0xf bank_mask:0xf
    v_max3_f32 v46, v46, v88, v89
    s_waitcnt vmcnt(23)
    v_mfma_f32_16x16x32_bf16 v[16:19], v[160:163], v[4:7], 0
    s_add_u32 s47, s47, 0x1000
    buffer_load_dwordx4 v[160:163], v1, s[4:7], s47 offen nt
    v_mov_b32_dpp v90, v8 quad_perm:[0,0,0,0] row_mask:0xf bank_mask:0xf
    v_add_f32_dpp v90, v9, v90 quad_perm:[1,1,1,1] row_mask:0xf bank_mask:0xf
    v_add_f32_dpp v90, v10, v90 quad_perm:[2,2,2,2] row_mask:0xf bank_mask:0xf
    v_add_f32_dpp v90, v11, v90 quad_perm:[3,3,3,3] row_mask:0xf bank_mask:0xf
    s_waitcnt vmcnt(23)
    v_mfma_f32_16x16x32_bf16 v[20:23], v[164:167], v[4:7], 0
    s_add_u32 s47, s47, 0x1000
    buffer_load_dwordx4 v[164:167], v1, s[4:7], s47 offen nt
    v_mov_b32_dpp v91, v12 quad_perm:[0,0,0,0] row_mask:0xf bank_mask:0xf
    v_add_f32_dpp v91, v13, v91 quad_perm:[1,1,1,1] row_mask:0xf bank_mask:0xf
    v_add_f32_dpp v91, v14, v91 quad_perm:[2,2,2,2] row_mask:0xf bank_mask:0xf
    v_add_f32_dpp v91, v15, v91 quad_perm:[3,3,3,3] row_mask:0xf bank_mask:0xf
    v_max3_f32 v46, v46, v90, v91
    s_waitcnt vmcnt(23)
    v_mfma_f32_16x16x32_bf16 v[8:11], v[168:171], v[4:7], 0
    s_add_u32 s47, s47, 0x1000
    buffer_load_dwordx4 v[168:171], v1, s[4:7], s47 offen nt
    v_mov_b32_dpp v92, v16 quad_perm:[0,0,0,0] row_mask:0xf bank_mask:0xf
    v_add_f32_dpp v92, v17, v92 quad_perm:[1,1,1,1] row_mask:0xf bank_mask:0xf
    v_add_f32_dpp v92, v18, v92 quad_perm:[2,2,2,2] row_mask:0xf bank_mask:0xf
    v_add_f32_dpp v92, v19, v92 quad_perm:[3,3,3,3] row_mask:0xf bank_mask:0xf
    s_waitcnt vmcnt(23)
    v_mfma_f32_16x16x32_bf16 v[12:15], v[172:175], v[4:7], 0
    s_add_u32 s47, s47, 0x1000
    buffer_load_dwordx4 v[172:175], v1, s[4:7], s47 offen nt
    v_mov_b32_dpp v93, v20 quad_perm:[0,0,0,0] row_mask:0xf bank_mask:0xf
    v_add_f32_dpp v93, v21, v93 quad_perm:[1,1,1,1] row_mask:0xf bank_mask:0xf
    v_add_f32_dpp v93, v22, v93 quad_perm:[2,2,2,2] row_mask:0xf bank_mask:0xf
    v_add_f32_dpp v93, v23, v93 quad_perm:[3,3,3,3] row_mask:0xf bank_mask:0xf
    v_max3_f32 v46, v46, v92, v93
    s_waitcnt vmcnt(23)
    v_mfma_f32_16x16x32_bf16 v[16:19], v[176:179], v[4:7], 0
    s_add_u32 s47, s47, 0x1000
    buffer_load_dwordx4 v[176:179], v1, s[4:7], s47 offen nt
    v_mov_b32_dpp v94, v8 quad_perm:[0,0,0,0] row_mask:0xf bank_mask:0xf
    v_add_f32_dpp v94, v9, v94 quad_perm:[1,1,1,1] row_mask:0xf bank_mask:0xf
    v_add_f32_dpp v94, v10, v94 quad_perm:[2,2,2,2] row_mask:0xf bank_mask:0xf
    v_add_f32_dpp v94, v11, v94 quad_perm:[3,3,3,3] row_mask:0xf bank_mask:0xf
    s_waitcnt vmcnt(23)
    v_mfma_f32_16x16x32_bf16 v[20:23], v[180:183], v[4:7], 0
    s_add_u32 s47, s47, 0x1000
    buffer_load_dwordx4 v[180:183], v1, s[4:7], s47 offen nt
    v_mov_b32_dpp v95, v12 quad_perm:[0,0,0,0] row_mask:0xf bank_mask:0xf
    v_add_f32_dpp v95, v13, v95 quad_perm:[1,1,1,1] row_mask:0xf bank_mask:0xf
    v_add_f32_dpp v95, v14, v95 quad_perm:[2,2,2,2] row_mask:0xf bank_mask:0xf
    v_add_f32_dpp v95, v15, v95 quad_perm:[3,3,3,3] row_mask:0xf bank_mask:0xf
    v_max3_f32 v46, v46, v94, v95
    s_waitcnt vmcnt(23)
    v_mfma_f32_16x16x32_bf16 v[8:11], v[184:187], v[4:7], 0
    s_add_u32 s47, s47, 0x1000
    buffer_load_dwordx4 v[184:187], v1, s[4:7], s47 offen nt
    v_mov_b32_dpp v96, v16 quad_perm:[0,0,0,0] row_mask:0xf bank_mask:0xf
    v_add_f32_dpp v96, v17, v96 quad_perm:[1,1,1,1] row_mask:0xf bank_mask:0xf
    v_add_f32_dpp v96, v18, v96 quad_perm:[2,2,2,2] row_mask:0xf bank_mask:0xf
    v_add_f32_dpp v96, v19, v96 quad_perm:[3,3,3,3] row_mask:0xf bank_mask:0xf
    s_waitcnt vmcnt(23)
    v_mfma_f32_16x16x32_bf16 v[12:15], v[188:191], v[4:7], 0
    buffer_load_dwordx4 v[188:191], v2, s[8:11], s48 offen nt
    v_mov_b32_dpp v97, v20 quad_perm:[0,0,0,0] row_mask:0xf bank_mask:0xf
    v_add_f32_dpp v97, v21, v97 quad_perm:[1,1,1,1] row_mask:0xf bank_mask:0xf
    v_add_f32_dpp v97, v22, v97 quad_perm:[2,2,2,2] row_mask:0xf bank_mask:0xf
    v_add_f32_dpp v97, v23, v97 quad_perm:[3,3,3,3] row_mask:0xf bank_mask:0xf
    v_max3_f32 v46, v46, v96, v97
    s_waitcnt vmcnt(23)
    v_mfma_f32_16x16x32_bf16 v[16:19], v[192:195], v[4:7], 0
    s_add_u32 s48, s48, 0x1000
    buffer_load_dwordx4 v[192:195], v2, s[8:11], s48 offen nt
    v_mov_b32_dpp v98, v8 quad_perm:[0,0,0,0] row_mask:0xf bank_mask:0xf
    v_add_f32_dpp v98, v9, v98 quad_perm:[1,1,1,1] row_mask:0xf bank_mask:0xf
    v_add_f32_dpp v98, v10, v98 quad_perm:[2,2,2,2] row_mask:0xf bank_mask:0xf
    v_add_f32_dpp v98, v11, v98 quad_perm:[3,3,3,3] row_mask:0xf bank_mask:0xf
    s_waitcnt vmcnt(23)
    v_mfma_f32_16x16x32_bf16 v[20:23], v[196:199], v[4:7], 0
    s_add_u32 s48, s48, 0x1000
    buffer_load_dwordx4 v[196:199], v2, s[8:11], s48 offen nt
    v_mov_b32_dpp v99, v12 quad_perm:[0,0,0,0] row_mask:0xf bank_mask:0xf
    v_add_f32_dpp v99, v13, v99 quad_perm:[1,1,1,1] row_mask:0xf bank_mask:0xf
    v_add_f32_dpp v99, v14, v99 quad_perm:[2,2,2,2] row_mask:0xf bank_mask:0xf
    v_add_f32_dpp v99, v15, v99 quad_perm:[3,3,3,3] row_mask:0xf bank_mask:0xf
    v_max3_f32 v46, v46, v98, v99
    s_waitcnt vmcnt(23)
    v_mfma_f32_16x16x32_bf16 v[8:11], v[200:203], v[4:7], 0
    s_add_u32 s48, s48, 0x1000
    buffer_load_dwordx4 v[200:203], v2, s[8:11], s48 offen nt
    v_mov_b32_dpp v100, v16 quad_perm:[0,0,0,0] row_mask:0xf bank_mask:0xf
    v_add_f32_dpp v100, v17, v100 quad_perm:[1,1,1,1] row_mask:0xf bank_mask:0xf
    v_add_f32_dpp v100, v18, v100 quad_perm:[2,2,2,2] row_mask:0xf bank_mask:0xf
    v_add_f32_dpp v100, v19, v100 quad_perm:[3,3,3,3] row_mask:0xf bank_mask:0xf
    s_waitcnt vmcnt(23)
    v_mfma_f32_16x16x32_bf16 v[12:15], v[204:207], v[4:7], 0
    s_add_u32 s48, s48, 0x1000
    buffer_load_dwordx4 v[204:207], v2, s[8:11], s48 offen nt
    v_mov_b32_dpp v101, v20 quad_perm:[0,0,0,0] row_mask:0xf bank_mask:0xf
    v_add_f32_dpp v101, v21, v101 quad_perm:[1,1,1,1] row_mask:0xf bank_mask:0xf
    v_add_f32_dpp v101, v22, v101 quad_perm:[2,2,2,2] row_mask:0xf bank_mask:0xf
    v_add_f32_dpp v101, v23, v101 quad_perm:[3,3,3,3] row_mask:0xf bank_mask:0xf
    v_max3_f32 v46, v46, v100, v101
    s_waitcnt vmcnt(23)
    v_mfma_f32_16x16x32_bf16 v[16:19], v[208:211], v[4:7], 0
    s_add_u32 s48, s48, 0x1000
    buffer_load_dwordx4 v[208:211], v2, s[8:11], s48 offen nt
    v_mov_b32_dpp v102, v8 quad_perm:[0,0,0,0] row_mask:0xf bank_mask:0xf
    v_add_f32_dpp v102, v9, v102 quad_perm:[1,1,1,1] row_mask:0xf bank_mask:0xf
    v_add_f32_dpp v102, v10, v102 quad_perm:[2,2,2,2] row_mask:0xf bank_mask:0xf
    v_add_f32_dpp v102, v11, v102 quad_perm:[3,3,3,3] row_mask:0xf bank_mask:0xf
    s_waitcnt vmcnt(23)
    v_mfma_f32_16x16x32_bf16 v[20:23], v[212:215], v[4:7], 0
    s_add_u32 s48, s48, 0x1000
    buffer_load_dwordx4 v[212:215], v2, s[8:11], s48 offen nt
    v_mov_b32_dpp v103, v12 quad_perm:[0,0,0,0] row_mask:0xf bank_mask:0xf
    v_add_f32_dpp v103, v13, v103 quad_perm:[1,1,1,1] row_mask:0xf bank_mask:0xf
    v_add_f32_dpp v103, v14, v103 quad_perm:[2,2,2,2] row_mask:0xf bank_mask:0xf
    v_add_f32_dpp v103, v15, v103 quad_perm:[3,3,3,3] row_mask:0xf bank_mask:0xf
    v_max3_f32 v46, v46, v102, v103
    s_waitcnt vmcnt(23)
    v_mfma_f32_16x16x32_bf16 v[8:11], v[216:219], v[4:7], 0
    s_add_u32 s48, s48, 0x1000
    buffer_load_dwordx4 v[216:219], v2, s[8:11], s48 offen nt
    v_mov_b32_dpp v104, v16 quad_perm:[0,0,0,0] row_mask:0xf bank_mask:0xf
    v_add_f32_dpp v104, v17, v104 quad_perm:[1,1,1,1] row_mask:0xf bank_mask:0xf
    v_add_f32_dpp v104, v18, v104 quad_perm:[2,2,2,2] row_mask:0xf bank_mask:0xf
    v_add_f32_dpp v104, v19, v104 quad_perm:[3,3,3,3] row_mask:0xf bank_mask:0xf
    s_waitcnt vmcnt(23)
    v_mfma_f32_16x16x32_bf16 v[12:15], v[124:127], v[4:7], 0
    s_add_u32 s48, s48, 0x1000
    buffer_load_dwordx4 v[124:127], v2, s[8:11], s48 offen nt
    v_mov_b32_dpp v105, v20 quad_perm:[0,0,0,0] row_mask:0xf bank_mask:0xf
    v_add_f32_dpp v105, v21, v105 quad_perm:[1,1,1,1] row_mask:0xf bank_mask:0xf
    v_add_f32_dpp v105, v22, v105 quad_perm:[2,2,2,2] row_mask:0xf bank_mask:0xf
    v_add_f32_dpp v105, v23, v105 quad_perm:[3,3,3,3] row_mask:0xf bank_mask:0xf
    v_max3_f32 v46, v46, v104, v105
    s_waitcnt vmcnt(23)
    v_mfma_f32_16x16x32_bf16 v[16:19], v[128:131], v[4:7], 0
    s_add_u32 s48, s48, 0x1000
    buffer_load_dwordx4 v[128:131], v2, s[8:11], s48 offen nt
    v_mov_b32_dpp v106, v8 quad_perm:[0,0,0,0] row_mask:0xf bank_mask:0xf
    v_add_f32_dpp v106, v9, v106 quad_perm:[1,1,1,1] row_mask:0xf bank_mask:0xf
    v_add_f32_dpp v106, v10, v106 quad_perm:[2,2,2,2] row_mask:0xf bank_mask:0xf
    v_add_f32_dpp v106, v11, v106 quad_perm:[3,3,3,3] row_mask:0xf bank_mask:0xf
    s_waitcnt vmcnt(23)
    v_mfma_f32_16x16x32_bf16 v[20:23], v[132:135], v[4:7], 0
    s_add_u32 s48, s48, 0x1000
    buffer_load_dwordx4 v[132:135], v2, s[8:11], s48 offen nt
    v_mov_b32_dpp v107, v12 quad_perm:[0,0,0,0] row_mask:0xf bank_mask:0xf
    v_add_f32_dpp v107, v13, v107 quad_perm:[1,1,1,1] row_mask:0xf bank_mask:0xf
    v_add_f32_dpp v107, v14, v107 quad_perm:[2,2,2,2] row_mask:0xf bank_mask:0xf
    v_add_f32_dpp v107, v15, v107 quad_perm:[3,3,3,3] row_mask:0xf bank_mask:0xf
    v_max3_f32 v46, v46, v106, v107
    s_waitcnt vmcnt(23)
    v_mfma_f32_16x16x32_bf16 v[8:11], v[136:139], v[4:7], 0
    s_add_u32 s48, s48, 0x1000
    buffer_load_dwordx4 v[136:139], v2, s[8:11], s48 offen nt
    v_mov_b32_dpp v108, v16 quad_perm:[0,0,0,0] row_mask:0xf bank_mask:0xf
    v_add_f32_dpp v108, v17, v108 quad_perm:[1,1,1,1] row_mask:0xf bank_mask:0xf
    v_add_f32_dpp v108, v18, v108 quad_perm:[2,2,2,2] row_mask:0xf bank_mask:0xf
    v_add_f32_dpp v108, v19, v108 quad_perm:[3,3,3,3] row_mask:0xf bank_mask:0xf
    s_waitcnt vmcnt(23)
    v_mfma_f32_16x16x32_bf16 v[12:15], v[140:143], v[4:7], 0
    s_add_u32 s48, s48, 0x1000
    buffer_load_dwordx4 v[140:143], v2, s[8:11], s48 offen nt
    v_mov_b32_dpp v109, v20 quad_perm:[0,0,0,0] row_mask:0xf bank_mask:0xf
    v_add_f32_dpp v109, v21, v109 quad_perm:[1,1,1,1] row_mask:0xf bank_mask:0xf
    v_add_f32_dpp v109, v22, v109 quad_perm:[2,2,2,2] row_mask:0xf bank_mask:0xf
    v_add_f32_dpp v109, v23, v109 quad_perm:[3,3,3,3] row_mask:0xf bank_mask:0xf
    v_max3_f32 v46, v46, v108, v109
    s_waitcnt vmcnt(23)
    v_mfma_f32_16x16x32_bf16 v[16:19], v[144:147], v[4:7], 0
    s_add_u32 s48, s48, 0x1000
    buffer_load_dwordx4 v[144:147], v2, s[8:11], s48 offen nt
    v_mov_b32_dpp v110, v8 quad_perm:[0,0,0,0] row_mask:0xf bank_mask:0xf
    v_add_f32_dpp v110, v9, v110 quad_perm:[1,1,1,1] row_mask:0xf bank_mask:0xf
    v_add_f32_dpp v110, v10, v110 quad_perm:[2,2,2,2] row_mask:0xf bank_mask:0xf
    v_add_f32_dpp v110, v11, v110 quad_perm:[3,3,3,3] row_mask:0xf bank_mask:0xf
    s_waitcnt vmcnt(23)
    v_mfma_f32_16x16x32_bf16 v[20:23], v[148:151], v[4:7], 0
    s_add_u32 s48, s48, 0x1000
    buffer_load_dwordx4 v[148:151], v2, s[8:11], s48 offen nt
    v_mov_b32_dpp v111, v12 quad_perm:[0,0,0,0] row_mask:0xf bank_mask:0xf
    v_add_f32_dpp v111, v13, v111 quad_perm:[1,1,1,1] row_mask:0xf bank_mask:0xf
    v_add_f32_dpp v111, v14, v111 quad_perm:[2,2,2,2] row_mask:0xf bank_mask:0xf
    v_add_f32_dpp v111, v15, v111 quad_perm:[3,3,3,3] row_mask:0xf bank_mask:0xf
    v_max3_f32 v46, v46, v110, v111
    s_waitcnt vmcnt(23)
    v_mfma_f32_16x16x32_bf16 v[8:11], v[152:155], v[4:7], 0
    s_add_u32 s48, s48, 0x1000
    buffer_load_dwordx4 v[152:155], v2, s[8:11], s48 offen nt
    v_mov_b32_dpp v112, v16 quad_perm:[0,0,0,0] row_mask:0xf bank_mask:0xf
    v_add_f32_dpp v112, v17, v112 quad_perm:[1,1,1,1] row_mask:0xf bank_mask:0xf
    v_add_f32_dpp v112, v18, v112 quad_perm:[2,2,2,2] row_mask:0xf bank_mask:0xf
    v_add_f32_dpp v112, v19, v112 quad_perm:[3,3,3,3] row_mask:0xf bank_mask:0xf
    s_waitcnt vmcnt(23)
    v_mfma_f32_16x16x32_bf16 v[12:15], v[156:159], v[4:7], 0
    s_add_u32 s48, s48, 0x1000
    buffer_load_dwordx4 v[156:159], v2, s[8:11], s48 offen nt
    v_mov_b32_dpp v113, v20 quad_perm:[0,0,0,0] row_mask:0xf bank_mask:0xf
    v_add_f32_dpp v113, v21, v113 quad_perm:[1,1,1,1] row_mask:0xf bank_mask:0xf
    v_add_f32_dpp v113, v22, v113 quad_perm:[2,2,2,2] row_mask:0xf bank_mask:0xf
    v_add_f32_dpp v113, v23, v113 quad_perm:[3,3,3,3] row_mask:0xf bank_mask:0xf
    v_max3_f32 v46, v46, v112, v113
    s_waitcnt vmcnt(23)
    v_mfma_f32_16x16x32_bf16 v[16:19], v[160:163], v[4:7], 0
    s_add_u32 s48, s48, 0x1000
    buffer_load_dwordx4 v[160:163], v2, s[8:11], s48 offen nt
    v_mov_b32_dpp v114, v8 quad_perm:[0,0,0,0] row_mask:0xf bank_mask:0xf
    v_add_f32_dpp v114, v9, v114 quad_perm:[1,1,1,1] row_mask:0xf bank_mask:0xf
    v_add_f32_dpp v114, v10, v114 quad_perm:[2,2,2,2] row_mask:0xf bank_mask:0xf
    v_add_f32_dpp v114, v11, v114 quad_perm:[3,3,3,3] row_mask:0xf bank_mask:0xf
    s_waitcnt vmcnt(23)
    v_mfma_f32_16x16x32_bf16 v[20:23], v[164:167], v[4:7], 0
    s_add_u32 s48, s48, 0x1000
    buffer_load_dwordx4 v[164:167], v2, s[8:11], s48 offen nt
    v_mov_b32_dpp v115, v12 quad_perm:[0,0,0,0] row_mask:0xf bank_mask:0xf
    v_add_f32_dpp v115, v13, v115 quad_perm:[1,1,1,1] row_mask:0xf bank_mask:0xf
    v_add_f32_dpp v115, v14, v115 quad_perm:[2,2,2,2] row_mask:0xf bank_mask:0xf
    v_add_f32_dpp v115, v15, v115 quad_perm:[3,3,3,3] row_mask:0xf bank_mask:0xf
    v_max3_f32 v46, v46, v114, v115
    s_waitcnt vmcnt(23)
    v_mfma_f32_16x16x32_bf16 v[8:11], v[168:171], v[4:7], 0
    s_add_u32 s48, s48, 0x1000
    buffer_load_dwordx4 v[168:171], v2, s[8:11], s48 offen nt
    v_mov_b32_dpp v116, v16 quad_perm:[0,0,0,0] row_mask:0xf bank_mask:0xf
    v_add_f32_dpp v116, v17, v116 quad_perm:[1,1,1,1] row_mask:0xf bank_mask:0xf
    v_add_f32_dpp v116, v18, v116 quad_perm:[2,2,2,2] row_mask:0xf bank_mask:0xf
    v_add_f32_dpp v116, v19, v116 quad_perm:[3,3,3,3] row_mask:0xf bank_mask:0xf
    s_waitcnt vmcnt(23)
    v_mfma_f32_16x16x32_bf16 v[12:15], v[172:175], v[4:7], 0
    s_add_u32 s48, s48, 0x1000
    buffer_load_dwordx4 v[172:175], v2, s[8:11], s48 offen nt
    v_mov_b32_dpp v117, v20 quad_perm:[0,0,0,0] row_mask:0xf bank_mask:0xf
    v_add_f32_dpp v117, v21, v117 quad_perm:[1,1,1,1] row_mask:0xf bank_mask:0xf
    v_add_f32_dpp v117, v22, v117 quad_perm:[2,2,2,2] row_mask:0xf bank_mask:0xf
    v_add_f32_dpp v117, v23, v117 quad_perm:[3,3,3,3] row_mask:0xf bank_mask:0xf
    v_max3_f32 v46, v46, v116, v117
    s_waitcnt vmcnt(23)
    v_mfma_f32_16x16x32_bf16 v[16:19], v[176:179], v[4:7], 0
    s_add_u32 s48, s48, 0x1000
    buffer_load_dwordx4 v[176:179], v2, s[8:11], s48 offen nt
    v_mov_b32_dpp v118, v8 quad_perm:[0,0,0,0] row_mask:0xf bank_mask:0xf
    v_add_f32_dpp v118, v9, v118 quad_perm:[1,1,1,1] row_mask:0xf bank_mask:0xf
    v_add_f32_dpp v118, v10, v118 quad_perm:[2,2,2,2] row_mask:0xf bank_mask:0xf
    v_add_f32_dpp v118, v11, v118 quad_perm:[3,3,3,3] row_mask:0xf bank_mask:0xf
    s_waitcnt vmcnt(23)
    v_mfma_f32_16x16x32_bf16 v[20:23], v[180:183], v[4:7], 0
    s_add_u32 s48, s48, 0x1000
    buffer_load_dwordx4 v[180:183], v2, s[8:11], s48 offen nt
    v_mov_b32_dpp v119, v12 quad_perm:[0,0,0,0] row_mask:0xf bank_mask:0xf
    v_add_f32_dpp v119, v13, v119 quad_perm:[1,1,1,1] row_mask:0xf bank_mask:0xf
    v_add_f32_dpp v119, v14, v119 quad_perm:[2,2,2,2] row_mask:0xf bank_mask:0xf
    v_add_f32_dpp v119, v15, v119 quad_perm:[3,3,3,3] row_mask:0xf bank_mask:0xf
    v_max3_f32 v46, v46, v118, v119
    s_waitcnt vmcnt(23)
    v_mfma_f32_16x16x32_bf16 v[8:11], v[184:187], v[4:7], 0
    s_add_u32 s48, s48, 0x1000
    buffer_load_dwordx4 v[184:187], v2, s[8:11], s48 offen nt
    v_mov_b32_dpp v120, v16 quad_perm:[0,0,0,0] row_mask:0xf bank_mask:0xf
    v_add_f32_dpp v120, v17, v120 quad_perm:[1,1,1,1] row_mask:0xf bank_mask:0xf
    v_add_f32_dpp v120, v18, v120 quad_perm:[2,2,2,2] row_mask:0xf bank_mask:0xf
    v_add_f32_dpp v120, v19, v120 quad_perm:[3,3,3,3] row_mask:0xf bank_mask:0xf
    v_mov_b32_dpp v121, v20 quad_perm:[0,0,0,0] row_mask:0xf bank_mask:0xf
    v_add_f32_dpp v121, v21, v121 quad_perm:[1,1,1,1] row_mask:0xf bank_mask:0xf
    v_add_f32_dpp v121, v22, v121 quad_perm:[2,2,2,2] row_mask:0xf bank_mask:0xf
    v_add_f32_dpp v121, v23, v121 quad_perm:[3,3,3,3] row_mask:0xf bank_mask:0xf
    v_mov_b32_dpp v122, v8 quad_perm:[0,0,0,0] row_mask:0xf bank_mask:0xf
    v_add_f32_dpp v122, v9, v122 quad_perm:[1,1,1,1] row_mask:0xf bank_mask:0xf
    v_add_f32_dpp v122, v10, v122 quad_perm:[2,2,2,2] row_mask:0xf bank_mask:0xf
    v_add_f32_dpp v122, v11, v122 quad_perm:[3,3,3,3] row_mask:0xf bank_mask:0xf
    v_max3_f32 v46, v46, v120, v121
    v_max_f32 v46, v46, v122
    v_mov_b32 v3, v46
    s_nop 1
    v_permlane16_swap_b32 v46, v3
    s_nop 1
    v_max_f32 v46, v46, v3
    v_mov_b32 v3, v46
    s_nop 1
    v_permlane32_swap_b32 v46, v3
    s_nop 1
    v_max_f32 v46, v46, v3
    ds_write_b32 v45, v46 offset:0
    v_bfe_u32 v36, v0, 3, 1
    v_lshlrev_b32 v36, 4, v36
    s_waitcnt lgkmcnt(0)
    s_barrier
    ds_read_b128 v[8:11], v36 offset:0
    s_waitcnt lgkmcnt(0)
    v_max3_f32 v46, v46, v8, v9
    v_max3_f32 v46, v46, v10, v11
    v_mul_f32 v46, s44, v46
    v_sub_f32 v47, 0, v46
    v_fma_f32 v123, v123, s44, v47
    v_exp_f32 v123, v123
    v_fma_f32 v59, v59, s44, v47
    v_exp_f32 v59, v59
    v_fma_f32 v60, v60, s44, v47
    v_exp_f32 v60, v60
    v_fma_f32 v61, v61, s44, v47
    v_exp_f32 v61, v61
    v_mov_b32 v39, v123
    v_cvt_pk_bf16_f32 v123, v123, v123
    v_add_f32 v39, v39, v59
    v_cvt_pk_bf16_f32 v59, v59, v59
    v_add_f32 v39, v39, v60
    v_cvt_pk_bf16_f32 v60, v60, v60
    v_and_b32 v8, v123, v32
    v_and_b32 v9, v123, v33
    v_and_b32 v10, v123, v34
    v_and_b32 v11, v123, v35
    v_and_b32 v12, v59, v32
    v_and_b32 v13, v59, v33
    v_and_b32 v14, v59, v34
    v_and_b32 v15, v59, v35
    v_mfma_f32_16x16x32_bf16 v[40:43], v[8:11], v[28:31], v[40:43]
    v_fma_f32 v62, v62, s44, v47
    v_exp_f32 v62, v62
    v_fma_f32 v63, v63, s44, v47
    v_exp_f32 v63, v63
    v_fma_f32 v64, v64, s44, v47
    v_exp_f32 v64, v64
    v_fma_f32 v65, v65, s44, v47
    v_exp_f32 v65, v65
    v_add_f32 v39, v39, v61
    v_cvt_pk_bf16_f32 v61, v61, v61
    v_and_b32 v16, v60, v32
    v_and_b32 v17, v60, v33
    v_and_b32 v18, v60, v34
    v_and_b32 v19, v60, v35
    s_waitcnt vmcnt(23)
    v_mfma_f32_16x16x32_bf16 v[40:43], v[12:15], v[188:191], v[40:43]
    s_add_u32 s48, s48, 0x1000
    buffer_load_dwordx4 v[188:191], v2, s[8:11], s48 offen nt
    v_fma_f32 v66, v66, s44, v47
    v_exp_f32 v66, v66
    v_fma_f32 v67, v67, s44, v47
    v_exp_f32 v67, v67
    v_fma_f32 v68, v68, s44, v47
    v_exp_f32 v68, v68
    v_fma_f32 v69, v69, s44, v47
    v_exp_f32 v69, v69
    v_add_f32 v39, v39, v62
    v_cvt_pk_bf16_f32 v62, v62, v62
    v_add_f32 v39, v39, v63
    v_cvt_pk_bf16_f32 v63, v63, v63
    v_add_f32 v39, v39, v64
    v_cvt_pk_bf16_f32 v64, v64, v64
    v_add_f32 v39, v39, v65
    v_cvt_pk_bf16_f32 v65, v65, v65
    v_and_b32 v20, v61, v32
    v_and_b32 v21, v61, v33
    v_and_b32 v22, v61, v34
    v_and_b32 v23, v61, v35
    s_waitcnt vmcnt(23)
    v_mfma_f32_16x16x32_bf16 v[40:43], v[16:19], v[192:195], v[40:43]
    s_add_u32 s48, s48, 0x1000
    buffer_load_dwordx4 v[192:195], v2, s[8:11], s48 offen nt
    v_fma_f32 v70, v70, s44, v47
    v_exp_f32 v70, v70
    v_fma_f32 v71, v71, s44, v47
    v_exp_f32 v71, v71
    v_fma_f32 v72, v72, s44, v47
    v_exp_f32 v72, v72
    v_fma_f32 v73, v73, s44, v47
    v_exp_f32 v73, v73
    v_add_f32 v39, v39, v66
    v_cvt_pk_bf16_f32 v66, v66, v66
    v_add_f32 v39, v39, v67
    v_cvt_pk_bf16_f32 v67, v67, v67
    v_add_f32 v39, v39, v68
    v_cvt_pk_bf16_f32 v68, v68, v68
    v_add_f32 v39, v39, v69
    v_cvt_pk_bf16_f32 v69, v69, v69
    v_and_b32 v8, v62, v32
    v_and_b32 v9, v62, v33
    v_and_b32 v10, v62, v34
    v_and_b32 v11, v62, v35
    s_waitcnt vmcnt(23)
    v_mfma_f32_16x16x32_bf16 v[40:43], v[20:23], v[196:199], v[40:43]
    s_add_u32 s48, s48, 0x1000
    buffer_load_dwordx4 v[196:199], v2, s[8:11], s48 offen nt
    v_fma_f32 v74, v74, s44, v47
    v_exp_f32 v74, v74
    v_fma_f32 v75, v75, s44, v47
    v_exp_f32 v75, v75
    v_fma_f32 v76, v76, s44, v47
    v_exp_f32 v76, v76
    v_fma_f32 v77, v77, s44, v47
    v_exp_f32 v77, v77
    v_add_f32 v39, v39, v70
    v_cvt_pk_bf16_f32 v70, v70, v70
    v_add_f32 v39, v39, v71
    v_cvt_pk_bf16_f32 v71, v71, v71
    v_add_f32 v39, v39, v72
    v_cvt_pk_bf16_f32 v72, v72, v72
    v_add_f32 v39, v39, v73
    v_cvt_pk_bf16_f32 v73, v73, v73
    v_and_b32 v12, v63, v32
    v_and_b32 v13, v63, v33
    v_and_b32 v14, v63, v34
    v_and_b32 v15, v63, v35
    s_waitcnt vmcnt(23)
    v_mfma_f32_16x16x32_bf16 v[40:43], v[8:11], v[200:203], v[40:43]
    s_add_u32 s48, s48, 0x1000
    buffer_load_dwordx4 v[200:203], v2, s[8:11], s48 offen nt
    v_fma_f32 v78, v78, s44, v47
    v_exp_f32 v78, v78
    v_fma_f32 v79, v79, s44, v47
    v_exp_f32 v79, v79
    v_fma_f32 v80, v80, s44, v47
    v_exp_f32 v80, v80
    v_fma_f32 v81, v81, s44, v47
    v_exp_f32 v81, v81
    v_add_f32 v39, v39, v74
    v_cvt_pk_bf16_f32 v74, v74, v74
    v_add_f32 v39, v39, v75
    v_cvt_pk_bf16_f32 v75, v75, v75
    v_add_f32 v39, v39, v76
    v_cvt_pk_bf16_f32 v76, v76, v76
    v_add_f32 v39, v39, v77
    v_cvt_pk_bf16_f32 v77, v77, v77
    v_and_b32 v16, v64, v32
    v_and_b32 v17, v64, v33
    v_and_b32 v18, v64, v34
    v_and_b32 v19, v64, v35
    s_waitcnt vmcnt(23)
    v_mfma_f32_16x16x32_bf16 v[40:43], v[12:15], v[204:207], v[40:43]
    s_add_u32 s48, s48, 0x1000
    buffer_load_dwordx4 v[204:207], v2, s[8:11], s48 offen nt
    v_fma_f32 v82, v82, s44, v47
    v_exp_f32 v82, v82
    v_fma_f32 v83, v83, s44, v47
    v_exp_f32 v83, v83
    v_fma_f32 v84, v84, s44, v47
    v_exp_f32 v84, v84
    v_fma_f32 v85, v85, s44, v47
    v_exp_f32 v85, v85
    v_add_f32 v39, v39, v78
    v_cvt_pk_bf16_f32 v78, v78, v78
    v_add_f32 v39, v39, v79
    v_cvt_pk_bf16_f32 v79, v79, v79
    v_add_f32 v39, v39, v80
    v_cvt_pk_bf16_f32 v80, v80, v80
    v_add_f32 v39, v39, v81
    v_cvt_pk_bf16_f32 v81, v81, v81
    v_and_b32 v20, v65, v32
    v_and_b32 v21, v65, v33
    v_and_b32 v22, v65, v34
    v_and_b32 v23, v65, v35
    s_waitcnt vmcnt(23)
    v_mfma_f32_16x16x32_bf16 v[40:43], v[16:19], v[208:211], v[40:43]
    s_add_u32 s48, s48, 0x1000
    buffer_load_dwordx4 v[208:211], v2, s[8:11], s48 offen nt
    v_fma_f32 v86, v86, s44, v47
    v_exp_f32 v86, v86
    v_fma_f32 v87, v87, s44, v47
    v_exp_f32 v87, v87
    v_fma_f32 v88, v88, s44, v47
    v_exp_f32 v88, v88
    v_fma_f32 v89, v89, s44, v47
    v_exp_f32 v89, v89
    v_add_f32 v39, v39, v82
    v_cvt_pk_bf16_f32 v82, v82, v82
    v_add_f32 v39, v39, v83
    v_cvt_pk_bf16_f32 v83, v83, v83
    v_add_f32 v39, v39, v84
    v_cvt_pk_bf16_f32 v84, v84, v84
    v_add_f32 v39, v39, v85
    v_cvt_pk_bf16_f32 v85, v85, v85
    v_and_b32 v8, v66, v32
    v_and_b32 v9, v66, v33
    v_and_b32 v10, v66, v34
    v_and_b32 v11, v66, v35
    s_waitcnt vmcnt(23)
    v_mfma_f32_16x16x32_bf16 v[40:43], v[20:23], v[212:215], v[40:43]
    s_add_u32 s48, s48, 0x1000
    buffer_load_dwordx4 v[212:215], v2, s[8:11], s48 offen nt
    v_fma_f32 v90, v90, s44, v47
    v_exp_f32 v90, v90
    v_fma_f32 v91, v91, s44, v47
    v_exp_f32 v91, v91
    v_fma_f32 v92, v92, s44, v47
    v_exp_f32 v92, v92
    v_fma_f32 v93, v93, s44, v47
    v_exp_f32 v93, v93
    v_add_f32 v39, v39, v86
    v_cvt_pk_bf16_f32 v86, v86, v86
    v_add_f32 v39, v39, v87
    v_cvt_pk_bf16_f32 v87, v87, v87
    v_add_f32 v39, v39, v88
    v_cvt_pk_bf16_f32 v88, v88, v88
    v_add_f32 v39, v39, v89
    v_cvt_pk_bf16_f32 v89, v89, v89
    v_and_b32 v12, v67, v32
    v_and_b32 v13, v67, v33
    v_and_b32 v14, v67, v34
    v_and_b32 v15, v67, v35
    s_waitcnt vmcnt(23)
    v_mfma_f32_16x16x32_bf16 v[40:43], v[8:11], v[216:219], v[40:43]
    s_add_u32 s48, s48, 0x1000
    buffer_load_dwordx4 v[216:219], v2, s[8:11], s48 offen nt
    v_fma_f32 v94, v94, s44, v47
    v_exp_f32 v94, v94
    v_fma_f32 v95, v95, s44, v47
    v_exp_f32 v95, v95
    v_fma_f32 v96, v96, s44, v47
    v_exp_f32 v96, v96
    v_fma_f32 v97, v97, s44, v47
    v_exp_f32 v97, v97
    v_add_f32 v39, v39, v90
    v_cvt_pk_bf16_f32 v90, v90, v90
    v_add_f32 v39, v39, v91
    v_cvt_pk_bf16_f32 v91, v91, v91
    v_add_f32 v39, v39, v92
    v_cvt_pk_bf16_f32 v92, v92, v92
    v_add_f32 v39, v39, v93
    v_cvt_pk_bf16_f32 v93, v93, v93
    v_and_b32 v16, v68, v32
    v_and_b32 v17, v68, v33
    v_and_b32 v18, v68, v34
    v_and_b32 v19, v68, v35
    s_waitcnt vmcnt(23)
    v_mfma_f32_16x16x32_bf16 v[40:43], v[12:15], v[124:127], v[40:43]
    s_add_u32 s48, s48, 0x1000
    buffer_load_dwordx4 v[124:127], v2, s[8:11], s48 offen nt
    v_fma_f32 v98, v98, s44, v47
    v_exp_f32 v98, v98
    v_fma_f32 v99, v99, s44, v47
    v_exp_f32 v99, v99
    v_fma_f32 v100, v100, s44, v47
    v_exp_f32 v100, v100
    v_fma_f32 v101, v101, s44, v47
    v_exp_f32 v101, v101
    v_add_f32 v39, v39, v94
    v_cvt_pk_bf16_f32 v94, v94, v94
    v_add_f32 v39, v39, v95
    v_cvt_pk_bf16_f32 v95, v95, v95
    v_add_f32 v39, v39, v96
    v_cvt_pk_bf16_f32 v96, v96, v96
    v_add_f32 v39, v39, v97
    v_cvt_pk_bf16_f32 v97, v97, v97
    v_and_b32 v20, v69, v32
    v_and_b32 v21, v69, v33
    v_and_b32 v22, v69, v34
    v_and_b32 v23, v69, v35
    s_waitcnt vmcnt(23)
    v_mfma_f32_16x16x32_bf16 v[40:43], v[16:19], v[128:131], v[40:43]
    s_add_u32 s48, s48, 0x1000
    buffer_load_dwordx4 v[128:131], v2, s[8:11], s48 offen nt
    v_fma_f32 v102, v102, s44, v47
    v_exp_f32 v102, v102
    v_fma_f32 v103, v103, s44, v47
    v_exp_f32 v103, v103
    v_fma_f32 v104, v104, s44, v47
    v_exp_f32 v104, v104
    v_fma_f32 v105, v105, s44, v47
    v_exp_f32 v105, v105
    v_add_f32 v39, v39, v98
    v_cvt_pk_bf16_f32 v98, v98, v98
    v_add_f32 v39, v39, v99
    v_cvt_pk_bf16_f32 v99, v99, v99
    v_add_f32 v39, v39, v100
    v_cvt_pk_bf16_f32 v100, v100, v100
    v_add_f32 v39, v39, v101
    v_cvt_pk_bf16_f32 v101, v101, v101
    v_and_b32 v8, v70, v32
    v_and_b32 v9, v70, v33
    v_and_b32 v10, v70, v34
    v_and_b32 v11, v70, v35
    s_waitcnt vmcnt(23)
    v_mfma_f32_16x16x32_bf16 v[40:43], v[20:23], v[132:135], v[40:43]
    s_add_u32 s48, s48, 0x1000
    buffer_load_dwordx4 v[132:135], v2, s[8:11], s48 offen nt
    v_fma_f32 v106, v106, s44, v47
    v_exp_f32 v106, v106
    v_fma_f32 v107, v107, s44, v47
    v_exp_f32 v107, v107
    v_fma_f32 v108, v108, s44, v47
    v_exp_f32 v108, v108
    v_fma_f32 v109, v109, s44, v47
    v_exp_f32 v109, v109
    v_add_f32 v39, v39, v102
    v_cvt_pk_bf16_f32 v102, v102, v102
    v_add_f32 v39, v39, v103
    v_cvt_pk_bf16_f32 v103, v103, v103
    v_add_f32 v39, v39, v104
    v_cvt_pk_bf16_f32 v104, v104, v104
    v_add_f32 v39, v39, v105
    v_cvt_pk_bf16_f32 v105, v105, v105
    v_and_b32 v12, v71, v32
    v_and_b32 v13, v71, v33
    v_and_b32 v14, v71, v34
    v_and_b32 v15, v71, v35
    s_waitcnt vmcnt(23)
    v_mfma_f32_16x16x32_bf16 v[40:43], v[8:11], v[136:139], v[40:43]
    s_add_u32 s48, s48, 0x1000
    buffer_load_dwordx4 v[136:139], v2, s[8:11], s48 offen nt
    v_fma_f32 v110, v110, s44, v47
    v_exp_f32 v110, v110
    v_fma_f32 v111, v111, s44, v47
    v_exp_f32 v111, v111
    v_fma_f32 v112, v112, s44, v47
    v_exp_f32 v112, v112
    v_fma_f32 v113, v113, s44, v47
    v_exp_f32 v113, v113
    v_add_f32 v39, v39, v106
    v_cvt_pk_bf16_f32 v106, v106, v106
    v_add_f32 v39, v39, v107
    v_cvt_pk_bf16_f32 v107, v107, v107
    v_add_f32 v39, v39, v108
    v_cvt_pk_bf16_f32 v108, v108, v108
    v_add_f32 v39, v39, v109
    v_cvt_pk_bf16_f32 v109, v109, v109
    v_and_b32 v16, v72, v32
    v_and_b32 v17, v72, v33
    v_and_b32 v18, v72, v34
    v_and_b32 v19, v72, v35
    s_waitcnt vmcnt(23)
    v_mfma_f32_16x16x32_bf16 v[40:43], v[12:15], v[140:143], v[40:43]
    s_add_u32 s48, s48, 0x1000
    buffer_load_dwordx4 v[140:143], v2, s[8:11], s48 offen nt
    v_fma_f32 v114, v114, s44, v47
    v_exp_f32 v114, v114
    v_fma_f32 v115, v115, s44, v47
    v_exp_f32 v115, v115
    v_fma_f32 v116, v116, s44, v47
    v_exp_f32 v116, v116
    v_fma_f32 v117, v117, s44, v47
    v_exp_f32 v117, v117
    v_add_f32 v39, v39, v110
    v_cvt_pk_bf16_f32 v110, v110, v110
    v_add_f32 v39, v39, v111
    v_cvt_pk_bf16_f32 v111, v111, v111
    v_add_f32 v39, v39, v112
    v_cvt_pk_bf16_f32 v112, v112, v112
    v_add_f32 v39, v39, v113
    v_cvt_pk_bf16_f32 v113, v113, v113
    v_and_b32 v20, v73, v32
    v_and_b32 v21, v73, v33
    v_and_b32 v22, v73, v34
    v_and_b32 v23, v73, v35
    s_waitcnt vmcnt(23)
    v_mfma_f32_16x16x32_bf16 v[40:43], v[16:19], v[144:147], v[40:43]
    s_add_u32 s48, s48, 0x1000
    buffer_load_dwordx4 v[144:147], v2, s[8:11], s48 offen nt
    v_fma_f32 v118, v118, s44, v47
    v_exp_f32 v118, v118
    v_fma_f32 v119, v119, s44, v47
    v_exp_f32 v119, v119
    v_fma_f32 v120, v120, s44, v47
    v_exp_f32 v120, v120
    v_fma_f32 v121, v121, s44, v47
    v_exp_f32 v121, v121
    v_add_f32 v39, v39, v114
    v_cvt_pk_bf16_f32 v114, v114, v114
    v_add_f32 v39, v39, v115
    v_cvt_pk_bf16_f32 v115, v115, v115
    v_add_f32 v39, v39, v116
    v_cvt_pk_bf16_f32 v116, v116, v116
    v_add_f32 v39, v39, v117
    v_cvt_pk_bf16_f32 v117, v117, v117
    v_and_b32 v8, v74, v32
    v_and_b32 v9, v74, v33
    v_and_b32 v10, v74, v34
    v_and_b32 v11, v74, v35
    s_waitcnt vmcnt(23)
    v_mfma_f32_16x16x32_bf16 v[40:43], v[20:23], v[148:151], v[40:43]
    s_add_u32 s48, s48, 0x1000
    buffer_load_dwordx4 v[148:151], v2, s[8:11], s48 offen nt
    v_fma_f32 v122, v122, s44, v47
    v_exp_f32 v122, v122
    v_add_f32 v39, v39, v118
    v_cvt_pk_bf16_f32 v118, v118, v118
    v_add_f32 v39, v39, v119
    v_cvt_pk_bf16_f32 v119, v119, v119
    v_add_f32 v39, v39, v120
    v_cvt_pk_bf16_f32 v120, v120, v120
    v_add_f32 v39, v39, v121
    v_cvt_pk_bf16_f32 v121, v121, v121
    v_and_b32 v12, v75, v32
    v_and_b32 v13, v75, v33
    v_and_b32 v14, v75, v34
    v_and_b32 v15, v75, v35
    s_waitcnt vmcnt(23)
    v_mfma_f32_16x16x32_bf16 v[40:43], v[8:11], v[152:155], v[40:43]
    s_add_u32 s48, s48, 0x1000
    buffer_load_dwordx4 v[152:155], v2, s[8:11], s48 offen nt
    v_add_f32 v39, v39, v122
    v_cvt_pk_bf16_f32 v122, v122, v122
    v_mov_b32 v3, v39
    s_nop 1
    v_permlane16_swap_b32 v39, v3
    s_nop 1
    v_add_f32 v39, v39, v3
    v_mov_b32 v3, v39
    s_nop 1
    v_permlane32_swap_b32 v39, v3
    s_nop 1
    v_add_f32 v39, v39, v3
    ds_write_b32 v45, v39 offset:128
    v_lshlrev_b32 v28, 2, v0
    v_lshlrev_b32 v3, 4, v0
    v_lshrrev_b32 v37, 5, v44
    v_lshlrev_b32 v37, 4, v37
    v_readlane_b32 s45, v46, 0
    v_readlane_b32 s46, v46, 8
    v_cmp_gt_u32 vcc, 32, v44
    v_mov_b32 v36, s45
    v_mov_b32 v53, s46
    v_cndmask_b32 v52, v53, v36, vcc
    v_bfe_u32 v36, v44, 4, 1
    v_and_b32 v27, 3, v44
    v_lshlrev_b32 v27, 4, v27
    v_lshl_add_u32 v26, v36, 3, v27
    v_lshl_add_u32 v58, v36, 6, v27
    v_lshrrev_b32 v36, 2, v37
    v_add_u32 v26, v26, v36
    v_bfe_u32 v25, v44, 2, 2
    v_add_u32 v36, v36, v25
    v_lshl_add_u32 v27, v36, 7, v58
    v_lshl_add_u32 v58, v36, 10, v58
    v_and_b32 v36, 1, v44
    v_lshl_add_u32 v25, v36, 2, v25
    s_lshr_b32 s45, s41, 2
    v_lshl_add_u32 v25, v25, 1, s45
    v_lshlrev_b32 v25, 4, v25
    v_and_b32 v16, v76, v32
    v_and_b32 v17, v76, v33
    v_and_b32 v18, v76, v34
    v_and_b32 v19, v76, v35
    s_waitcnt vmcnt(23)
    v_mfma_f32_16x16x32_bf16 v[40:43], v[12:15], v[156:159], v[40:43]
    s_add_u32 s48, s48, 0x1000
    buffer_load_dwordx4 v[156:159], v2, s[8:11], s48 offen nt
    s_waitcnt lgkmcnt(0)
    s_barrier
    ds_read_b128 v[72:75], v37 offset:128
    v_and_b32 v20, v77, v32
    v_and_b32 v21, v77, v33
    v_and_b32 v22, v77, v34
    v_and_b32 v23, v77, v35
    s_waitcnt vmcnt(23)
    v_mfma_f32_16x16x32_bf16 v[40:43], v[16:19], v[160:163], v[40:43]
    s_add_u32 s48, s48, 0x1000
    buffer_load_dwordx4 v[160:163], v2, s[8:11], s48 offen nt
    s_cmp_lg_u32 s42, 0
    s_cbranch_scc1 L_skip_rec
    v_readfirstlane_b32 s59, v220
    s_waitcnt lgkmcnt(0)
    v_pk_add_f32 v[72:73], v[72:73], v[74:75]
    s_andn2_b32 s59, s59, 1
    s_mul_i32 s59, s59, 0x9e3779b1
    s_add_u32 s59, s59, 0x7f4a7c16
    v_add_f32 v53, v72, v73
    v_mov_b32 v54, s59
    v_mov_b32 v55, s38
    v_mov_b32 v64, 0xff
    s_mov_b32 exec_lo, 1
    s_mov_b32 exec_hi, 1
    buffer_store_dwordx4 v[52:55], v37, s[32:35], s39 offen
    s_mov_b64 exec, -1
    s_bfe_u32 s52, s59, 0x80000
    s_bfe_u32 s53, s59, 0x80008
    s_bfe_u32 s54, s59, 0x80010
    s_bfe_u32 s55, s59, 0x80018
L_skip_rec:
    v_and_b32 v8, v78, v32
    v_and_b32 v9, v78, v33
    v_and_b32 v10, v78, v34
    v_and_b32 v11, v78, v35
    s_waitcnt vmcnt(23)
    v_mfma_f32_16x16x32_bf16 v[40:43], v[20:23], v[164:167], v[40:43]
    s_add_u32 s48, s48, 0x1000
    buffer_load_dwordx4 v[164:167], v2, s[8:11], s48 offen nt
    v_and_b32 v12, v79, v32
    v_and_b32 v13, v79, v33
    v_and_b32 v14, v79, v34
    v_and_b32 v15, v79, v35
    s_waitcnt vmcnt(23)
    v_mfma_f32_16x16x32_bf16 v[40:43], v[8:11], v[168:171], v[40:43]
    s_add_u32 s48, s48, 0x1000
    buffer_load_dwordx4 v[168:171], v2, s[8:11], s48 offen nt
    v_and_b32 v16, v80, v32
    v_and_b32 v17, v80, v33
    v_and_b32 v18, v80, v34
    v_and_b32 v19, v80, v35
    s_waitcnt vmcnt(23)
    v_mfma_f32_16x16x32_bf16 v[40:43], v[12:15], v[172:175], v[40:43]
    s_add_u32 s48, s48, 0x1000
    buffer_load_dwordx4 v[172:175], v2, s[8:11], s48 offen nt
    v_and_b32 v20, v81, v32
    v_and_b32 v21, v81, v33
    v_and_b32 v22, v81, v34
    v_and_b32 v23, v81, v35
    s_waitcnt vmcnt(23)
    v_mfma_f32_16x16x32_bf16 v[40:43], v[16:19], v[176:179], v[40:43]
    s_add_u32 s48, s48, 0x1000
    buffer_load_dwordx4 v[176:179], v2, s[8:11], s48 offen nt
    v_and_b32 v8, v82, v32
    v_and_b32 v9, v82, v33
    v_and_b32 v10, v82, v34
    v_and_b32 v11, v82, v35
    s_waitcnt vmcnt(23)
    v_mfma_f32_16x16x32_bf16 v[40:43], v[20:23], v[180:183], v[40:43]
    s_add_u32 s48, s48, 0x1000
    buffer_load_dwordx4 v[180:183], v2, s[8:11], s48 offen nt
    v_and_b32 v12, v83, v32
    v_and_b32 v13, v83, v33
    v_and_b32 v14, v83, v34
    v_and_b32 v15, v83, v35
    s_waitcnt vmcnt(23)
    v_mfma_f32_16x16x32_bf16 v[40:43], v[8:11], v[184:187], v[40:43]
    s_add_u32 s48, s48, 0x1000
    buffer_load_dwordx4 v[184:187], v2, s[8:11], s48 offen nt
    v_and_b32 v16, v84, v32
    v_and_b32 v17, v84, v33
    v_and_b32 v18, v84, v34
    v_and_b32 v19, v84, v35
    s_waitcnt vmcnt(23)
    v_mfma_f32_16x16x32_bf16 v[40:43], v[12:15], v[188:191], v[40:43]
    s_add_u32 s48, s48, 0x1000
    buffer_load_dwordx4 v[188:191], v2, s[8:11], s48 offen nt
    v_and_b32 v20, v85, v32
    v_and_b32 v21, v85, v33
    v_and_b32 v22, v85, v34
    v_and_b32 v23, v85, v35
    s_waitcnt vmcnt(23)
    v_mfma_f32_16x16x32_bf16 v[40:43], v[16:19], v[192:195], v[40:43]
    s_add_u32 s48, s48, 0x1000
    buffer_load_dwordx4 v[192:195], v2, s[8:11], s48 offen nt
    v_and_b32 v8, v86, v32
    v_and_b32 v9, v86, v33
    v_and_b32 v10, v86, v34
    v_and_b32 v11, v86, v35
    s_waitcnt vmcnt(23)
    v_mfma_f32_16x16x32_bf16 v[40:43], v[20:23], v[196:199], v[40:43]
    s_add_u32 s48, s48, 0x1000
    buffer_load_dwordx4 v[196:199], v2, s[8:11], s48 offen nt
    v_and_b32 v12, v87, v32
    v_and_b32 v13, v87, v33
    v_and_b32 v14, v87, v34
    v_and_b32 v15, v87, v35
    s_waitcnt vmcnt(23)
    v_mfma_f32_16x16x32_bf16 v[40:43], v[8:11], v[200:203], v[40:43]
    s_add_u32 s48, s48, 0x1000
    buffer_load_dwordx4 v[200:203], v2, s[8:11], s48 offen nt
    v_and_b32 v16, v88, v32
    v_and_b32 v17, v88, v33
    v_and_b32 v18, v88, v34
    v_and_b32 v19, v88, v35
    s_waitcnt vmcnt(23)
    v_mfma_f32_16x16x32_bf16 v[40:43], v[12:15], v[204:207], v[40:43]
    s_add_u32 s48, s48, 0x1000
    buffer_load_dwordx4 v[204:207], v2, s[8:11], s48 offen nt
    v_and_b32 v20, v89, v32
    v_and_b32 v21, v89, v33
    v_and_b32 v22, v89, v34
    v_and_b32 v23, v89, v35
    s_waitcnt vmcnt(23)
    v_mfma_f32_16x16x32_bf16 v[40:43], v[16:19], v[208:211], v[40:43]
    s_add_u32 s48, s48, 0x1000
    buffer_load_dwordx4 v[208:211], v2, s[8:11], s48 offen nt
    s_cmp_lg_u32 s42, 0
    s_cbranch_scc1 L_skip_rl
    buffer_load_dwordx4 v[4:7], v25, s[32:35], s61 offen sc1
L_skip_rl:
    v_and_b32 v8, v90, v32
    v_and_b32 v9, v90, v33
    v_and_b32 v10, v90, v34
    v_and_b32 v11, v90, v35
    s_waitcnt vmcnt(23)
    v_mfma_f32_16x16x32_bf16 v[40:43], v[20:23], v[212:215], v[40:43]
    s_add_u32 s48, s48, 0x1000
    buffer_load_dwordx4 v[212:215], v2, s[8:11], s48 offen nt
    v_and_b32 v12, v91, v32
    v_and_b32 v13, v91, v33
    v_and_b32 v14, v91, v34
    v_and_b32 v15, v91, v35
    s_waitcnt vmcnt(23)
    v_mfma_f32_16x16x32_bf16 v[40:43], v[8:11], v[216:219], v[40:43]
    s_add_u32 s48, s48, 0x1000
    buffer_load_dwordx4 v[216:219], v2, s[8:11], s48 offen nt
    v_and_b32 v16, v92, v32
    v_and_b32 v17, v92, v33
    v_and_b32 v18, v92, v34
    v_and_b32 v19, v92, v35
    s_waitcnt vmcnt(23)
    v_mfma_f32_16x16x32_bf16 v[40:43], v[12:15], v[124:127], v[40:43]
    s_add_u32 s48, s48, 0x1000
    buffer_load_dwordx4 v[124:127], v2, s[8:11], s48 offen nt
    v_and_b32 v20, v93, v32
    v_and_b32 v21, v93, v33
    v_and_b32 v22, v93, v34
    v_and_b32 v23, v93, v35
    s_waitcnt vmcnt(23)
    v_mfma_f32_16x16x32_bf16 v[40:43], v[16:19], v[128:131], v[40:43]
    s_add_u32 s48, s48, 0x1000
    buffer_load_dwordx4 v[128:131], v2, s[8:11], s48 offen nt
    v_and_b32 v8, v94, v32
    v_and_b32 v9, v94, v33
    v_and_b32 v10, v94, v34
    v_and_b32 v11, v94, v35
    s_waitcnt vmcnt(23)
    v_mfma_f32_16x16x32_bf16 v[40:43], v[20:23], v[132:135], v[40:43]
    s_add_u32 s48, s48, 0x1000
    buffer_load_dwordx4 v[132:135], v2, s[8:11], s48 offen nt
    v_and_b32 v12, v95, v32
    v_and_b32 v13, v95, v33
    v_and_b32 v14, v95, v34
    v_and_b32 v15, v95, v35
    s_waitcnt vmcnt(23)
    v_mfma_f32_16x16x32_bf16 v[40:43], v[8:11], v[136:139], v[40:43]
    s_add_u32 s48, s48, 0x1000
    buffer_load_dwordx4 v[136:139], v2, s[8:11], s48 offen nt
    v_and_b32 v16, v96, v32
    v_and_b32 v17, v96, v33
    v_and_b32 v18, v96, v34
    v_and_b32 v19, v96, v35
    s_waitcnt vmcnt(23)
    v_mfma_f32_16x16x32_bf16 v[40:43], v[12:15], v[140:143], v[40:43]
    s_add_u32 s48, s48, 0x1000
    buffer_load_dwordx4 v[140:143], v2, s[8:11], s48 offen nt
    v_and_b32 v20, v97, v32
    v_and_b32 v21, v97, v33
    v_and_b32 v22, v97, v34
    v_and_b32 v23, v97, v35
    s_waitcnt vmcnt(23)
    v_mfma_f32_16x16x32_bf16 v[40:43], v[16:19], v[144:147], v[40:43]
    s_add_u32 s48, s48, 0x1000
    buffer_load_dwordx4 v[144:147], v2, s[8:11], s48 offen nt
    v_and_b32 v8, v98, v32
    v_and_b32 v9, v98, v33
    v_and_b32 v10, v98, v34
    v_and_b32 v11, v98, v35
    s_waitcnt vmcnt(23)
    v_mfma_f32_16x16x32_bf16 v[40:43], v[20:23], v[148:151], v[40:43]
    s_add_u32 s48, s48, 0x1000
    buffer_load_dwordx4 v[148:151], v2, s[8:11], s48 offen nt
    v_and_b32 v12, v99, v32
    v_and_b32 v13, v99, v33
    v_and_b32 v14, v99, v34
    v_and_b32 v15, v99, v35
    s_waitcnt vmcnt(23)
    v_mfma_f32_16x16x32_bf16 v[40:43], v[8:11], v[152:155], v[40:43]
    s_add_u32 s48, s48, 0x1000
    buffer_load_dwordx4 v[152:155], v2, s[8:11], s48 offen nt
    v_and_b32 v16, v100, v32
    v_and_b32 v17, v100, v33
    v_and_b32 v18, v100, v34
    v_and_b32 v19, v100, v35
    s_waitcnt vmcnt(23)
    v_mfma_f32_16x16x32_bf16 v[40:43], v[12:15], v[156:159], v[40:43]
    v_and_b32 v20, v101, v32
    v_and_b32 v21, v101, v33
    v_and_b32 v22, v101, v34
    v_and_b32 v23, v101, v35
    s_waitcnt vmcnt(22)
    v_mfma_f32_16x16x32_bf16 v[40:43], v[16:19], v[160:163], v[40:43]
    v_and_b32 v8, v102, v32
    v_and_b32 v9, v102, v33
    v_and_b32 v10, v102, v34
    v_and_b32 v11, v102, v35
    s_waitcnt vmcnt(21)
    v_mfma_f32_16x16x32_bf16 v[40:43], v[20:23], v[164:167], v[40:43]
    v_and_b32 v12, v103, v32
    v_and_b32 v13, v103, v33
    v_and_b32 v14, v103, v34
    v_and_b32 v15, v103, v35
    s_waitcnt vmcnt(20)
    v_mfma_f32_16x16x32_bf16 v[40:43], v[8:11], v[168:171], v[40:43]
    v_and_b32 v16, v104, v32
    v_and_b32 v17, v104, v33
    v_and_b32 v18, v104, v34
    v_and_b32 v19, v104, v35
    s_cmp_eq_u32 s42, 0
    s_cbranch_scc1 L_w0
    s_waitcnt vmcnt(19)
    v_mfma_f32_16x16x32_bf16 v[40:43], v[12:15], v[172:175], v[40:43]
    v_and_b32 v20, v105, v32
    v_and_b32 v21, v105, v33
    v_and_b32 v22, v105, v34
    v_and_b32 v23, v105, v35
    s_waitcnt vmcnt(18)
    v_mfma_f32_16x16x32_bf16 v[40:43], v[16:19], v[176:179], v[40:43]
    v_and_b32 v8, v106, v32
    v_and_b32 v9, v106, v33
    v_and_b32 v10, v106, v34
    v_and_b32 v11, v106, v35
    s_waitcnt vmcnt(17)
    v_mfma_f32_16x16x32_bf16 v[40:43], v[20:23], v[180:183], v[40:43]
    v_and_b32 v12, v107, v32
    v_and_b32 v13, v107, v33
    v_and_b32 v14, v107, v34
    v_and_b32 v15, v107, v35
    s_waitcnt vmcnt(16)
    v_mfma_f32_16x16x32_bf16 v[40:43], v[8:11], v[184:187], v[40:43]
    v_and_b32 v16, v108, v32
    v_and_b32 v17, v108, v33
    v_and_b32 v18, v108, v34
    v_and_b32 v19, v108, v35
    s_waitcnt vmcnt(15)
    v_mfma_f32_16x16x32_bf16 v[40:43], v[12:15], v[188:191], v[40:43]
    v_and_b32 v20, v109, v32
    v_and_b32 v21, v109, v33
    v_and_b32 v22, v109, v34
    v_and_b32 v23, v109, v35
    s_waitcnt vmcnt(14)
    v_mfma_f32_16x16x32_bf16 v[40:43], v[16:19], v[192:195], v[40:43]
    v_and_b32 v8, v110, v32
    v_and_b32 v9, v110, v33
    v_and_b32 v10, v110, v34
    v_and_b32 v11, v110, v35
    s_waitcnt vmcnt(13)
    v_mfma_f32_16x16x32_bf16 v[40:43], v[20:23], v[196:199], v[40:43]
    v_and_b32 v12, v111, v32
    v_and_b32 v13, v111, v33
    v_and_b32 v14, v111, v34
    v_and_b32 v15, v111, v35
    s_waitcnt vmcnt(12)
    v_mfma_f32_16x16x32_bf16 v[40:43], v[8:11], v[200:203], v[40:43]
    v_and_b32 v16, v112, v32
    v_and_b32 v17, v112, v33
    v_and_b32 v18, v112, v34
    v_and_b32 v19, v112, v35
    s_waitcnt vmcnt(11)
    v_mfma_f32_16x16x32_bf16 v[40:43], v[12:15], v[204:207], v[40:43]
    v_and_b32 v20, v113, v32
    v_and_b32 v21, v113, v33
    v_and_b32 v22, v113, v34
    v_and_b32 v23, v113, v35
    s_waitcnt vmcnt(10)
    v_mfma_f32_16x16x32_bf16 v[40:43], v[16:19], v[208:211], v[40:43]
    v_and_b32 v8, v114, v32
    v_and_b32 v9, v114, v33
    v_and_b32 v10, v114, v34
    v_and_b32 v11, v114, v35
    s_waitcnt vmcnt(9)
    v_mfma_f32_16x16x32_bf16 v[40:43], v[20:23], v[212:215], v[40:43]
    v_and_b32 v12, v115, v32
    v_and_b32 v13, v115, v33
    v_and_b32 v14, v115, v34
    v_and_b32 v15, v115, v35
    s_waitcnt vmcnt(8)
    v_mfma_f32_16x16x32_bf16 v[40:43], v[8:11], v[216:219], v[40:43]
    v_and_b32 v16, v116, v32
    v_and_b32 v17, v116, v33
    v_and_b32 v18, v116, v34
    v_and_b32 v19, v116, v35
    s_waitcnt vmcnt(7)
    v_mfma_f32_16x16x32_bf16 v[40:43], v[12:15], v[124:127], v[40:43]
    v_and_b32 v20, v117, v32
    v_and_b32 v21, v117, v33
    v_and_b32 v22, v117, v34
    v_and_b32 v23, v117, v35
    s_waitcnt vmcnt(6)
    v_mfma_f32_16x16x32_bf16 v[40:43], v[16:19], v[128:131], v[40:43]
    v_and_b32 v8, v118, v32
    v_and_b32 v9, v118, v33
    v_and_b32 v10, v118, v34
    v_and_b32 v11, v118, v35
    s_waitcnt vmcnt(5)
    v_mfma_f32_16x16x32_bf16 v[40:43], v[20:23], v[132:135], v[40:43]
    v_and_b32 v12, v119, v32
    v_and_b32 v13, v119, v33
    v_and_b32 v14, v119, v34
    v_and_b32 v15, v119, v35
    s_waitcnt vmcnt(4)
    v_mfma_f32_16x16x32_bf16 v[40:43], v[8:11], v[136:139], v[40:43]
    v_and_b32 v16, v120, v32
    v_and_b32 v17, v120, v33
    v_and_b32 v18, v120, v34
    v_and_b32 v19, v120, v35
    s_waitcnt vmcnt(3)
    v_mfma_f32_16x16x32_bf16 v[40:43], v[12:15], v[140:143], v[40:43]
    v_and_b32 v20, v121, v32
    v_and_b32 v21, v121, v33
    v_and_b32 v22, v121, v34
    v_and_b32 v23, v121, v35
    s_waitcnt vmcnt(2)
    v_mfma_f32_16x16x32_bf16 v[40:43], v[16:19], v[144:147], v[40:43]
    v_and_b32 v8, v122, v32
    v_and_b32 v9, v122, v33
    v_and_b32 v10, v122, v34
    v_and_b32 v11, v122, v35
    s_waitcnt vmcnt(1)
    v_mfma_f32_16x16x32_bf16 v[40:43], v[20:23], v[148:151], v[40:43]
    s_waitcnt vmcnt(0)
    v_mfma_f32_16x16x32_bf16 v[40:43], v[8:11], v[152:155], v[40:43]
    s_nop 7
    ds_write_b128 v3, v[40:43] offset:256
    s_waitcnt lgkmcnt(0)
    s_barrier
    s_endpgm
L_w0:
    s_waitcnt lgkmcnt(0)
    buffer_load_dwordx4 v[68:71], v56, s[32:35], s49 offen
    s_waitcnt vmcnt(20)
    v_mfma_f32_16x16x32_bf16 v[40:43], v[12:15], v[172:175], v[40:43]
    v_and_b32 v20, v105, v32
    v_and_b32 v21, v105, v33
    v_and_b32 v22, v105, v34
    v_and_b32 v23, v105, v35
    s_waitcnt vmcnt(19)
    v_mfma_f32_16x16x32_bf16 v[40:43], v[16:19], v[176:179], v[40:43]
    v_and_b32 v8, v106, v32
    v_and_b32 v9, v106, v33
    v_and_b32 v10, v106, v34
    v_and_b32 v11, v106, v35
    s_waitcnt vmcnt(18)
    v_mfma_f32_16x16x32_bf16 v[40:43], v[20:23], v[180:183], v[40:43]
    v_and_b32 v12, v107, v32
    v_and_b32 v13, v107, v33
    v_and_b32 v14, v107, v34
    v_and_b32 v15, v107, v35
    s_waitcnt vmcnt(17)
    v_mfma_f32_16x16x32_bf16 v[40:43], v[8:11], v[184:187], v[40:43]
    v_and_b32 v16, v108, v32
    v_and_b32 v17, v108, v33
    v_and_b32 v18, v108, v34
    v_and_b32 v19, v108, v35
    s_mov_b64 exec, 1
    buffer_atomic_add v57, off, s[28:31], s58 sc0 sc1
    s_mov_b64 exec, -1
    s_waitcnt vmcnt(17)
    v_mfma_f32_16x16x32_bf16 v[40:43], v[12:15], v[188:191], v[40:43]
    v_and_b32 v20, v109, v32
    v_and_b32 v21, v109, v33
    v_and_b32 v22, v109, v34
    v_and_b32 v23, v109, v35
    s_waitcnt vmcnt(16)
    v_mfma_f32_16x16x32_bf16 v[40:43], v[16:19], v[192:195], v[40:43]
    v_and_b32 v8, v110, v32
    v_and_b32 v9, v110, v33
    v_and_b32 v10, v110, v34
    v_and_b32 v11, v110, v35
    s_waitcnt vmcnt(15)
    v_mfma_f32_16x16x32_bf16 v[40:43], v[20:23], v[196:199], v[40:43]
    v_and_b32 v12, v111, v32
    v_and_b32 v13, v111, v33
    v_and_b32 v14, v111, v34
    v_and_b32 v15, v111, v35
    s_waitcnt vmcnt(14)
    v_mfma_f32_16x16x32_bf16 v[40:43], v[8:11], v[200:203], v[40:43]
    v_and_b32 v16, v112, v32
    v_and_b32 v17, v112, v33
    v_and_b32 v18, v112, v34
    v_and_b32 v19, v112, v35
    s_waitcnt vmcnt(13)
    v_mfma_f32_16x16x32_bf16 v[40:43], v[12:15], v[204:207], v[40:43]
    v_and_b32 v20, v113, v32
    v_and_b32 v21, v113, v33
    v_and_b32 v22, v113, v34
    v_and_b32 v23, v113, v35
    s_waitcnt vmcnt(12)
    v_mfma_f32_16x16x32_bf16 v[40:43], v[16:19], v[208:211], v[40:43]
    v_and_b32 v8, v114, v32
    v_and_b32 v9, v114, v33
    v_and_b32 v10, v114, v34
    v_and_b32 v11, v114, v35
    s_waitcnt vmcnt(11)
    v_mfma_f32_16x16x32_bf16 v[40:43], v[20:23], v[212:215], v[40:43]
    v_and_b32 v12, v115, v32
    v_and_b32 v13, v115, v33
    v_and_b32 v14, v115, v34
    v_and_b32 v15, v115, v35
    v_mov_b32 v72, v4
    v_xor_b32 v6, s59, v6
    v_xor_b32 v7, s38, v7
    s_nop 1
    v_max_f32_dpp v72, v72, v72 quad_perm:[1,0,3,2] row_mask:0xf bank_mask:0xf
    s_nop 1
    v_max_f32_dpp v72, v72, v72 row_ror:8 row_mask:0xf bank_mask:0xf
    s_nop 1
    v_max_f32_dpp v72, v72, v72 row_ror:4 row_mask:0xf bank_mask:0xf
    v_or_b32 v6, v6, v7
    v_sub_f32 v4, v4, v72
    v_exp_f32 v4, v4
    v_cmp_ne_u32 vcc, 0, v6
    v_mul_f32 v72, v4, v5
    s_nop 1
    v_add_f32_dpp v72, v72, v72 quad_perm:[1,0,3,2] row_mask:0xf bank_mask:0xf
    s_nop 1
    v_add_f32_dpp v72, v72, v72 row_ror:8 row_mask:0xf bank_mask:0xf
    s_nop 1
    v_add_f32_dpp v72, v72, v72 row_ror:4 row_mask:0xf bank_mask:0xf
    v_rcp_f32 v72, v72
    s_nop 0
    v_mul_f32 v72, v4, v72
    s_nop 1
    v_mov_b32_dpp v60, v72 quad_perm:[0,0,0,0] row_mask:0xf bank_mask:0xf
    v_mov_b32_dpp v61, v72 quad_perm:[1,1,1,1] row_mask:0xf bank_mask:0xf
    s_waitcnt vmcnt(10)
    v_mfma_f32_16x16x32_bf16 v[40:43], v[8:11], v[216:219], v[40:43]
    v_and_b32 v16, v116, v32
    v_and_b32 v17, v116, v33
    v_and_b32 v18, v116, v34
    v_and_b32 v19, v116, v35
    s_waitcnt vmcnt(9)
    v_mfma_f32_16x16x32_bf16 v[40:43], v[12:15], v[124:127], v[40:43]
    v_and_b32 v20, v117, v32
    v_and_b32 v21, v117, v33
    v_and_b32 v22, v117, v34
    v_and_b32 v23, v117, v35
    s_waitcnt vmcnt(8)
    v_mfma_f32_16x16x32_bf16 v[40:43], v[16:19], v[128:131], v[40:43]
    v_and_b32 v8, v118, v32
    v_and_b32 v9, v118, v33
    v_and_b32 v10, v118, v34
    v_and_b32 v11, v118, v35
    s_waitcnt vmcnt(7)
    v_mfma_f32_16x16x32_bf16 v[40:43], v[20:23], v[132:135], v[40:43]
    v_and_b32 v12, v119, v32
    v_and_b32 v13, v119, v33
    v_and_b32 v14, v119, v34
    v_and_b32 v15, v119, v35
    s_waitcnt vmcnt(6)
    v_mfma_f32_16x16x32_bf16 v[40:43], v[8:11], v[136:139], v[40:43]
    v_and_b32 v16, v120, v32
    v_and_b32 v17, v120, v33
    v_and_b32 v18, v120, v34
    v_and_b32 v19, v120, v35
    s_waitcnt vmcnt(5)
    v_mfma_f32_16x16x32_bf16 v[40:43], v[12:15], v[140:143], v[40:43]
    v_and_b32 v20, v121, v32
    v_and_b32 v21, v121, v33
    v_and_b32 v22, v121, v34
    v_and_b32 v23, v121, v35
    s_waitcnt vmcnt(4)
    v_mfma_f32_16x16x32_bf16 v[40:43], v[16:19], v[144:147], v[40:43]
    v_and_b32 v8, v122, v32
    v_and_b32 v9, v122, v33
    v_and_b32 v10, v122, v34
    v_and_b32 v11, v122, v35
    s_waitcnt vmcnt(3)
    v_mfma_f32_16x16x32_bf16 v[40:43], v[20:23], v[148:151], v[40:43]
    s_waitcnt vmcnt(2)
    v_mfma_f32_16x16x32_bf16 v[40:43], v[8:11], v[152:155], v[40:43]
    s_barrier
    ds_read_b128 v[80:83], v56 offset:1280
    ds_read_b128 v[84:87], v56 offset:2304
    ds_read_b128 v[88:91], v56 offset:3328
    s_waitcnt lgkmcnt(1)
    v_pk_add_f32 v[80:81], v[80:81], v[84:85]
    v_pk_add_f32 v[82:83], v[82:83], v[86:87]
    s_nop 0
    v_pk_add_f32 v[80:81], v[80:81], v[40:41]
    v_pk_add_f32 v[82:83], v[82:83], v[42:43]
    s_waitcnt lgkmcnt(0)
    v_pk_add_f32 v[48:49], v[88:89], v[80:81]
    v_pk_add_f32 v[50:51], v[90:91], v[82:83]
    v_bfi_b32 v48, v64, s52, v48
    v_bfi_b32 v49, v64, s53, v49
    v_bfi_b32 v50, v64, s54, v50
    v_bfi_b32 v51, v64, s55, v51
    s_cbranch_vccnz L_retry
L_pub:
    buffer_store_dwordx4 v[48:51], v58, s[32:35], s50 offen
    buffer_load_dwordx4 v[92:95], v27, s[32:35], s49 offen sc1
    buffer_load_dwordx4 v[96:99], v27, s[32:35], s49 offen sc1
    buffer_load_dwordx4 v[100:103], v27, s[32:35], s49 offen sc1
    s_waitcnt vmcnt(2)
    v_xor_b32 v92, s52, v92
    v_xor_b32 v94, s54, v94
    v_xor_b32 v93, s53, v93
    v_xor_b32 v95, s55, v95
    v_permlane32_swap_b32 v92, v94
    v_or3_b32 v72, v92, v93, v95
    v_permlane32_swap_b32 v93, v95
    v_bitop3_b32 v72, v72, v94, v64 bitop3:0xa8
    v_pk_mul_f32 v[16:17], v[92:93], v[60:61] op_sel_hi:[1,0]
    v_cmp_lt_u32 vcc, 1, v72
    v_pk_fma_f32 v[16:17], v[94:95], v[60:61], v[16:17] op_sel:[0,1,0] op_sel_hi:[1,1,1]
    s_cbranch_vccnz L_more
L_fin:
    s_nop 0
    v_add_f32_dpp v16, v16, v16 row_ror:8 row_mask:0xf bank_mask:0xf
    v_add_f32_dpp v17, v17, v17 row_ror:8 row_mask:0xf bank_mask:0xf
    v_readfirstlane_b32 s45, v57
    v_add_f32_dpp v16, v16, v16 row_ror:4 row_mask:0xf bank_mask:0xf
    v_add_f32_dpp v17, v17, v17 row_ror:4 row_mask:0xf bank_mask:0xf
    v_cvt_pk_bf16_f32 v16, v16, v17
    buffer_store_dword v16, v26, s[24:27], s63 offen
    s_cmp_lg_u32 s45, s62
    s_cbranch_scc1 L_end
    v_cmp_ne_u32 vcc, 0, v72
    s_cbranch_vccnz L_slow
L_bump:
    v_mov_b32 v16, s59
    s_mov_b64 exec, 1
    buffer_store_dword v16, off, s[32:35], s61 offset:256
L_end:
    s_endpgm
L_more:
    buffer_load_dwordx4 v[92:95], v27, s[32:35], s49 offen sc1
    s_waitcnt vmcnt(2)
    v_xor_b32 v96, s52, v96
    v_xor_b32 v98, s54, v98
    v_xor_b32 v97, s53, v97
    v_xor_b32 v99, s55, v99
    v_permlane32_swap_b32 v96, v98
    v_or3_b32 v72, v96, v97, v99
    v_permlane32_swap_b32 v97, v99
    v_bitop3_b32 v72, v72, v98, v64 bitop3:0xa8
    v_pk_mul_f32 v[16:17], v[96:97], v[60:61] op_sel_hi:[1,0]
    v_cmp_lt_u32 vcc, 1, v72
    v_pk_fma_f32 v[16:17], v[98:99], v[60:61], v[16:17] op_sel:[0,1,0] op_sel_hi:[1,1,1]
    s_cbranch_vccz L_fin
    buffer_load_dwordx4 v[96:99], v27, s[32:35], s49 offen sc1
    s_waitcnt vmcnt(2)
    v_xor_b32 v100, s52, v100
    v_xor_b32 v102, s54, v102
    v_xor_b32 v101, s53, v101
    v_xor_b32 v103, s55, v103
    v_permlane32_swap_b32 v100, v102
    v_or3_b32 v72, v100, v101, v103
    v_permlane32_swap_b32 v101, v103
    v_bitop3_b32 v72, v72, v102, v64 bitop3:0xa8
    v_pk_mul_f32 v[16:17], v[100:101], v[60:61] op_sel_hi:[1,0]
    v_cmp_lt_u32 vcc, 1, v72
    v_pk_fma_f32 v[16:17], v[102:103], v[60:61], v[16:17] op_sel:[0,1,0] op_sel_hi:[1,1,1]
    s_cbranch_vccz L_fin
    buffer_load_dwordx4 v[100:103], v27, s[32:35], s49 offen sc1
    s_sub_u32 s60, s60, 1
    s_waitcnt vmcnt(2)
    v_xor_b32 v92, s52, v92
    v_xor_b32 v94, s54, v94
    v_xor_b32 v93, s53, v93
    v_xor_b32 v95, s55, v95
    v_permlane32_swap_b32 v92, v94
    v_or3_b32 v72, v92, v93, v95
    v_permlane32_swap_b32 v93, v95
    v_bitop3_b32 v72, v72, v94, v64 bitop3:0xa8
    v_pk_mul_f32 v[16:17], v[92:93], v[60:61] op_sel_hi:[1,0]
    v_cmp_lt_u32 vcc, 1, v72
    v_pk_fma_f32 v[16:17], v[94:95], v[60:61], v[16:17] op_sel:[0,1,0] op_sel_hi:[1,1,1]
    s_cbranch_vccz L_fin
    s_cbranch_scc0 L_more
    s_endpgm
L_retry:
    buffer_load_dwordx4 v[4:7], v25, s[32:35], s61 offen sc1
    s_waitcnt vmcnt(0)
    v_mov_b32 v72, v4
    v_xor_b32 v6, s59, v6
    v_xor_b32 v7, s38, v7
    s_nop 1
    v_max_f32_dpp v72, v72, v72 quad_perm:[1,0,3,2] row_mask:0xf bank_mask:0xf
    s_nop 1
    v_max_f32_dpp v72, v72, v72 row_ror:8 row_mask:0xf bank_mask:0xf
    s_nop 1
    v_max_f32_dpp v72, v72, v72 row_ror:4 row_mask:0xf bank_mask:0xf
    v_or_b32 v6, v6, v7
    v_sub_f32 v4, v4, v72
    v_exp_f32 v4, v4
    v_cmp_ne_u32 vcc, 0, v6
    v_mul_f32 v72, v4, v5
    s_nop 1
    v_add_f32_dpp v72, v72, v72 quad_perm:[1,0,3,2] row_mask:0xf bank_mask:0xf
    s_nop 1
    v_add_f32_dpp v72, v72, v72 row_ror:8 row_mask:0xf bank_mask:0xf
    s_nop 1
    v_add_f32_dpp v72, v72, v72 row_ror:4 row_mask:0xf bank_mask:0xf
    v_rcp_f32 v72, v72
    s_nop 0
    v_mul_f32 v72, v4, v72
    s_nop 1
    v_mov_b32_dpp v60, v72 quad_perm:[0,0,0,0] row_mask:0xf bank_mask:0xf
    v_mov_b32_dpp v61, v72 quad_perm:[1,1,1,1] row_mask:0xf bank_mask:0xf
    s_cbranch_vccz L_pub
    v_or_b32 v48, 1, v48
    v_readfirstlane_b32 s45, v57
    buffer_store_dwordx4 v[48:51], v58, s[32:35], s50 offen
    s_cmp_eq_u32 s45, s62
    s_cbranch_scc1 L_slow
    v_add_u32 v58, 0x4000, v58
    v_add_u32 v37, 0x4000, v37
    buffer_store_dwordx4 v[48:51], v58, s[32:35], s50 offen sc1
    s_mov_b32 exec_lo, 1
    s_mov_b32 exec_hi, 1
    buffer_store_dwordx4 v[52:55], v37, s[32:35], s39 offen sc1
    s_mov_b64 exec, -1
    s_lshr_b32 s62, s45, 4
    s_and_b32 s62, s62, 0xf0f0f0f
    s_and_b32 s45, s45, 0xf0f0f0f
    s_add_u32 s45, s45, s62
    s_mul_i32 s45, s45, 0x1010101
    s_lshr_b32 s45, s45, 24
    s_cmp_lg_u32 s45, 7
    s_cbranch_scc1 L_end
    v_add_u32 v27, 0x4000, v27
    v_add_u32 v25, 0x4000, v25
L_slow:
    v_and_b32 v25, 0xffffffef, v25
    s_add_u32 s50, s51, 0x1000
    s_lshl_b32 s46, s40, 9
L_slowpoll:
    buffer_load_dwordx4 v[188:191], v25, s[32:35], s61 offen sc1
    buffer_load_dwordx4 v[192:195], v25, s[32:35], s61 offen offset:16 sc1
    buffer_load_dwordx4 v[156:159], v27, s[32:35], s51 offen sc1
    buffer_load_dwordx4 v[160:163], v27, s[32:35], s51 offen offset:1024 sc1
    buffer_load_dwordx4 v[164:167], v27, s[32:35], s51 offen offset:2048 sc1
    buffer_load_dwordx4 v[168:171], v27, s[32:35], s51 offen offset:3072 sc1
    buffer_load_dwordx4 v[172:175], v27, s[32:35], s50 offen sc1
    buffer_load_dwordx4 v[176:179], v27, s[32:35], s50 offen offset:1024 sc1
    buffer_load_dwordx4 v[180:183], v27, s[32:35], s50 offen offset:2048 sc1
    buffer_load_dwordx4 v[184:187], v27, s[32:35], s50 offen offset:3072 sc1
    s_sub_u32 s60, s60, 1
    s_cbranch_scc1 L_end
    s_waitcnt vmcnt(0)
    v_bitop3_b32 v73, v190, v194, s59 bitop3:0x7e
    v_cmp_ne_u32 vcc, 0, v73
    s_cbranch_vccnz L_slowpoll
    v_xor_b32 v156, s52, v156
    v_xor_b32 v158, s54, v158
    v_xor_b32 v157, s53, v157
    v_xor_b32 v159, s55, v159
    v_permlane32_swap_b32 v156, v158
    v_or3_b32 v72, v156, v157, v159
    v_permlane32_swap_b32 v157, v159
    v_bitop3_b32 v72, v72, v158, v64 bitop3:0xa8
    v_or_b32 v73, v73, v72
    v_xor_b32 v160, s52, v160
    v_xor_b32 v162, s54, v162
    v_xor_b32 v161, s53, v161
    v_xor_b32 v163, s55, v163
    v_permlane32_swap_b32 v160, v162
    v_or3_b32 v72, v160, v161, v163
    v_permlane32_swap_b32 v161, v163
    v_bitop3_b32 v72, v72, v162, v64 bitop3:0xa8
    v_or_b32 v73, v73, v72
    v_xor_b32 v164, s52, v164
    v_xor_b32 v166, s54, v166
    v_xor_b32 v165, s53, v165
    v_xor_b32 v167, s55, v167
    v_permlane32_swap_b32 v164, v166
    v_or3_b32 v72, v164, v165, v167
    v_permlane32_swap_b32 v165, v167
    v_bitop3_b32 v72, v72, v166, v64 bitop3:0xa8
    v_or_b32 v73, v73, v72
    v_xor_b32 v168, s52, v168
    v_xor_b32 v170, s54, v170
    v_xor_b32 v169, s53, v169
    v_xor_b32 v171, s55, v171
    v_permlane32_swap_b32 v168, v170
    v_or3_b32 v72, v168, v169, v171
    v_permlane32_swap_b32 v169, v171
    v_bitop3_b32 v72, v72, v170, v64 bitop3:0xa8
    v_or_b32 v73, v73, v72
    v_xor_b32 v172, s52, v172
    v_xor_b32 v174, s54, v174
    v_xor_b32 v173, s53, v173
    v_xor_b32 v175, s55, v175
    v_permlane32_swap_b32 v172, v174
    v_or3_b32 v72, v172, v173, v175
    v_permlane32_swap_b32 v173, v175
    v_bitop3_b32 v72, v72, v174, v64 bitop3:0xa8
    v_or_b32 v73, v73, v72
    v_xor_b32 v176, s52, v176
    v_xor_b32 v178, s54, v178
    v_xor_b32 v177, s53, v177
    v_xor_b32 v179, s55, v179
    v_permlane32_swap_b32 v176, v178
    v_or3_b32 v72, v176, v177, v179
    v_permlane32_swap_b32 v177, v179
    v_bitop3_b32 v72, v72, v178, v64 bitop3:0xa8
    v_or_b32 v73, v73, v72
    v_xor_b32 v180, s52, v180
    v_xor_b32 v182, s54, v182
    v_xor_b32 v181, s53, v181
    v_xor_b32 v183, s55, v183
    v_permlane32_swap_b32 v180, v182
    v_or3_b32 v72, v180, v181, v183
    v_permlane32_swap_b32 v181, v183
    v_bitop3_b32 v72, v72, v182, v64 bitop3:0xa8
    v_or_b32 v73, v73, v72
    v_xor_b32 v184, s52, v184
    v_xor_b32 v186, s54, v186
    v_xor_b32 v185, s53, v185
    v_xor_b32 v187, s55, v187
    v_permlane32_swap_b32 v184, v186
    v_or3_b32 v72, v184, v185, v187
    v_permlane32_swap_b32 v185, v187
    v_bitop3_b32 v72, v72, v186, v64 bitop3:0xa8
    v_or_b32 v73, v73, v72
    v_cmp_lt_u32 vcc, 1, v73
    s_cbranch_vccnz L_slowpoll
    v_mov_b32 v72, v188
    s_nop 1
    v_max_f32_dpp v72, v72, v72 quad_perm:[1,0,3,2] row_mask:0xf bank_mask:0xf
    s_nop 1
    v_max_f32_dpp v72, v72, v72 row_ror:8 row_mask:0xf bank_mask:0xf
    s_nop 1
    v_max_f32_dpp v72, v72, v72 row_ror:4 row_mask:0xf bank_mask:0xf
    v_sub_f32 v188, v188, v72
    v_exp_f32 v188, v188
    s_nop 0
    v_mul_f32 v72, v188, v189
    s_nop 1
    v_add_f32_dpp v72, v72, v72 quad_perm:[1,0,3,2] row_mask:0xf bank_mask:0xf
    s_nop 1
    v_add_f32_dpp v72, v72, v72 row_ror:8 row_mask:0xf bank_mask:0xf
    s_nop 1
    v_add_f32_dpp v72, v72, v72 row_ror:4 row_mask:0xf bank_mask:0xf
    v_rcp_f32 v72, v72
    s_nop 0
    v_mul_f32 v72, v188, v72
    s_nop 1
    v_mov_b32_dpp v60, v72 quad_perm:[0,0,0,0] row_mask:0xf bank_mask:0xf
    v_mov_b32_dpp v61, v72 quad_perm:[1,1,1,1] row_mask:0xf bank_mask:0xf
    v_mov_b32 v72, v192
    s_nop 1
    v_max_f32_dpp v72, v72, v72 quad_perm:[1,0,3,2] row_mask:0xf bank_mask:0xf
    s_nop 1
    v_max_f32_dpp v72, v72, v72 row_ror:8 row_mask:0xf bank_mask:0xf
    s_nop 1
    v_max_f32_dpp v72, v72, v72 row_ror:4 row_mask:0xf bank_mask:0xf
    v_sub_f32 v192, v192, v72
    v_exp_f32 v192, v192
    s_nop 0
    v_mul_f32 v72, v192, v193
    s_nop 1
    v_add_f32_dpp v72, v72, v72 quad_perm:[1,0,3,2] row_mask:0xf bank_mask:0xf
    s_nop 1
    v_add_f32_dpp v72, v72, v72 row_ror:8 row_mask:0xf bank_mask:0xf
    s_nop 1
    v_add_f32_dpp v72, v72, v72 row_ror:4 row_mask:0xf bank_mask:0xf
    v_rcp_f32 v72, v72
    s_nop 0
    v_mul_f32 v72, v192, v72
    s_nop 1
    v_mov_b32_dpp v62, v72 quad_perm:[0,0,0,0] row_mask:0xf bank_mask:0xf
    v_mov_b32_dpp v63, v72 quad_perm:[1,1,1,1] row_mask:0xf bank_mask:0xf
    v_pk_mul_f32 v[16:17], v[156:157], v[60:61] op_sel_hi:[1,0]
    v_pk_fma_f32 v[16:17], v[158:159], v[60:61], v[16:17] op_sel:[0,1,0] op_sel_hi:[1,1,1]
    s_nop 1
    v_add_f32_dpp v16, v16, v16 row_ror:8 row_mask:0xf bank_mask:0xf
    v_add_f32_dpp v17, v17, v17 row_ror:8 row_mask:0xf bank_mask:0xf
    s_nop 0
    v_add_f32_dpp v16, v16, v16 row_ror:4 row_mask:0xf bank_mask:0xf
    v_add_f32_dpp v17, v17, v17 row_ror:4 row_mask:0xf bank_mask:0xf
    s_nop 0
    v_cvt_pk_bf16_f32 v156, v16, v17
    buffer_store_dword v156, v26, s[24:27], s46 offen
    v_pk_mul_f32 v[16:17], v[160:161], v[60:61] op_sel_hi:[1,0]
    v_pk_fma_f32 v[16:17], v[162:163], v[60:61], v[16:17] op_sel:[0,1,0] op_sel_hi:[1,1,1]
    s_nop 1
    v_add_f32_dpp v16, v16, v16 row_ror:8 row_mask:0xf bank_mask:0xf
    v_add_f32_dpp v17, v17, v17 row_ror:8 row_mask:0xf bank_mask:0xf
    s_nop 0
    v_add_f32_dpp v16, v16, v16 row_ror:4 row_mask:0xf bank_mask:0xf
    v_add_f32_dpp v17, v17, v17 row_ror:4 row_mask:0xf bank_mask:0xf
    s_nop 0
    v_cvt_pk_bf16_f32 v160, v16, v17
    buffer_store_dword v160, v26, s[24:27], s46 offen offset:64
    v_pk_mul_f32 v[16:17], v[164:165], v[60:61] op_sel_hi:[1,0]
    v_pk_fma_f32 v[16:17], v[166:167], v[60:61], v[16:17] op_sel:[0,1,0] op_sel_hi:[1,1,1]
    s_nop 1
    v_add_f32_dpp v16, v16, v16 row_ror:8 row_mask:0xf bank_mask:0xf
    v_add_f32_dpp v17, v17, v17 row_ror:8 row_mask:0xf bank_mask:0xf
    s_nop 0
    v_add_f32_dpp v16, v16, v16 row_ror:4 row_mask:0xf bank_mask:0xf
    v_add_f32_dpp v17, v17, v17 row_ror:4 row_mask:0xf bank_mask:0xf
    s_nop 0
    v_cvt_pk_bf16_f32 v164, v16, v17
    buffer_store_dword v164, v26, s[24:27], s46 offen offset:128
    v_pk_mul_f32 v[16:17], v[168:169], v[60:61] op_sel_hi:[1,0]
    v_pk_fma_f32 v[16:17], v[170:171], v[60:61], v[16:17] op_sel:[0,1,0] op_sel_hi:[1,1,1]
    s_nop 1
    v_add_f32_dpp v16, v16, v16 row_ror:8 row_mask:0xf bank_mask:0xf
    v_add_f32_dpp v17, v17, v17 row_ror:8 row_mask:0xf bank_mask:0xf
    s_nop 0
    v_add_f32_dpp v16, v16, v16 row_ror:4 row_mask:0xf bank_mask:0xf
    v_add_f32_dpp v17, v17, v17 row_ror:4 row_mask:0xf bank_mask:0xf
    s_nop 0
    v_cvt_pk_bf16_f32 v168, v16, v17
    buffer_store_dword v168, v26, s[24:27], s46 offen offset:192
    v_pk_mul_f32 v[16:17], v[172:173], v[62:63] op_sel_hi:[1,0]
    v_pk_fma_f32 v[16:17], v[174:175], v[62:63], v[16:17] op_sel:[0,1,0] op_sel_hi:[1,1,1]
    s_nop 1
    v_add_f32_dpp v16, v16, v16 row_ror:8 row_mask:0xf bank_mask:0xf
    v_add_f32_dpp v17, v17, v17 row_ror:8 row_mask:0xf bank_mask:0xf
    s_nop 0
    v_add_f32_dpp v16, v16, v16 row_ror:4 row_mask:0xf bank_mask:0xf
    v_add_f32_dpp v17, v17, v17 row_ror:4 row_mask:0xf bank_mask:0xf
    s_nop 0
    v_cvt_pk_bf16_f32 v172, v16, v17
    buffer_store_dword v172, v26, s[24:27], s46 offen offset:256
    v_pk_mul_f32 v[16:17], v[176:177], v[62:63] op_sel_hi:[1,0]
    v_pk_fma_f32 v[16:17], v[178:179], v[62:63], v[16:17] op_sel:[0,1,0] op_sel_hi:[1,1,1]
    s_nop 1
    v_add_f32_dpp v16, v16, v16 row_ror:8 row_mask:0xf bank_mask:0xf
    v_add_f32_dpp v17, v17, v17 row_ror:8 row_mask:0xf bank_mask:0xf
    s_nop 0
    v_add_f32_dpp v16, v16, v16 row_ror:4 row_mask:0xf bank_mask:0xf
    v_add_f32_dpp v17, v17, v17 row_ror:4 row_mask:0xf bank_mask:0xf
    s_nop 0
    v_cvt_pk_bf16_f32 v176, v16, v17
    buffer_store_dword v176, v26, s[24:27], s46 offen offset:320
    v_pk_mul_f32 v[16:17], v[180:181], v[62:63] op_sel_hi:[1,0]
    v_pk_fma_f32 v[16:17], v[182:183], v[62:63], v[16:17] op_sel:[0,1,0] op_sel_hi:[1,1,1]
    s_nop 1
    v_add_f32_dpp v16, v16, v16 row_ror:8 row_mask:0xf bank_mask:0xf
    v_add_f32_dpp v17, v17, v17 row_ror:8 row_mask:0xf bank_mask:0xf
    s_nop 0
    v_add_f32_dpp v16, v16, v16 row_ror:4 row_mask:0xf bank_mask:0xf
    v_add_f32_dpp v17, v17, v17 row_ror:4 row_mask:0xf bank_mask:0xf
    s_nop 0
    v_cvt_pk_bf16_f32 v180, v16, v17
    buffer_store_dword v180, v26, s[24:27], s46 offen offset:384
    v_pk_mul_f32 v[16:17], v[184:185], v[62:63] op_sel_hi:[1,0]
    v_pk_fma_f32 v[16:17], v[186:187], v[62:63], v[16:17] op_sel:[0,1,0] op_sel_hi:[1,1,1]
    s_nop 1
    v_add_f32_dpp v16, v16, v16 row_ror:8 row_mask:0xf bank_mask:0xf
    v_add_f32_dpp v17, v17, v17 row_ror:8 row_mask:0xf bank_mask:0xf
    s_nop 0
    v_add_f32_dpp v16, v16, v16 row_ror:4 row_mask:0xf bank_mask:0xf
    v_add_f32_dpp v17, v17, v17 row_ror:4 row_mask:0xf bank_mask:0xf
    s_nop 0
    v_cvt_pk_bf16_f32 v184, v16, v17
    buffer_store_dword v184, v26, s[24:27], s46 offen offset:448
    s_branch L_bump
.section .rodata,"a"
.p2align 6
.amdhsa_kernel standalone__tree_speculative_verify_tree_attention_over_candidate_token_tree__decode_kernel
  .amdhsa_next_free_vgpr 224
  .amdhsa_next_free_sgpr 64
  .amdhsa_accum_offset 224
  .amdhsa_group_segment_fixed_size 0
  .amdhsa_kernarg_size 72
  .amdhsa_user_sgpr_count 2
  .amdhsa_user_sgpr_kernarg_segment_ptr 1
  .amdhsa_system_sgpr_workgroup_id_x 1
  .amdhsa_float_denorm_mode_32 3
.end_amdhsa_kernel
```
